```python
import torch

def _softmax(x, axis=-1):
    return torch.softmax(x, dim=axis)
def _gelu(x):
    return torch.nn.functional.gelu(x, approximate="tanh")
def _silu(x):
    return torch.nn.functional.silu(x)
def _sigmoid(x):
    return torch.sigmoid(x)
def _layernorm(x, axis=-1, eps=1e-5):
    m = x.mean(dim=axis, keepdim=True)
    v = x.var(dim=axis, keepdim=True, unbiased=False)
    return (x - m) / torch.sqrt(v + eps)
def _scatter_add(tgt, idx, src, axis=0):
    return tgt.clone().index_add_(axis, idx, src)
def _segment_sum(src, seg, n):
    out = torch.zeros((n,) + src.shape[1:], dtype=src.dtype)
    return out.index_add_(0, seg, src)
def _pad(x, pw):
    flat = tuple(v for pair in reversed(pw) for v in pair)
    return torch.nn.functional.pad(x, flat)

kernel_name = 'gated_mix__ssm_conv_s4__softmax_full_mha__prompt'

def setup_inputs():

    _w = (lambda a: (lambda t: t.to(torch.bfloat16) if t.is_floating_point() else t)(torch.as_tensor(a)))
    def _A_setup():
        B, L, D, N = 1, 2048, 512, 128
        A_re = -(lambda _x: torch.exp(torch.as_tensor(_x)))((lambda *s: torch.randn(*s, dtype=torch.bfloat16) * 6.4)(D, N))
        A_im = torch.pi * (lambda *s: torch.randn(*s, dtype=torch.bfloat16) * 0.1)(D, N)
        B_re = (lambda *s: torch.randn(*s, dtype=torch.bfloat16) * 0.2)(D, N)
        B_im = (lambda *s: torch.randn(*s, dtype=torch.bfloat16) * 0.2)(D, N)
        C_re = (lambda *s: torch.randn(*s, dtype=torch.bfloat16) * 0.2)(D, N)
        C_im = (lambda *s: torch.randn(*s, dtype=torch.bfloat16) * 0.2)(D, N)
        log_dt = (lambda *s: torch.randn(*s, dtype=torch.bfloat16) * 0.1)(D) * 0.5 - 4.0
        Dskip = (lambda *s: torch.randn(*s, dtype=torch.bfloat16) * 0.1)(D)
        return {
            "u": _w((lambda *s: torch.randn(*s, dtype=torch.bfloat16) * 0.05)(B, L, D)),
            "A_re": _w(A_re),
            "A_im": _w(A_im),
            "B_re": _w(B_re),
            "B_im": _w(B_im),
            "C_re": _w(C_re),
            "C_im": _w(C_im),
            "log_dt": _w(log_dt),
            "Dskip": _w(Dskip),
        }
    _A_in = _A_setup()

    def _B_setup():
        B, S, D = 1, 2048, 512
        return {
            "x": _w((lambda *s: torch.randn(*s, dtype=torch.bfloat16) * 0.05)(B, S, D)),
            "wqkv": _w((lambda *s: torch.randn(*s, dtype=torch.bfloat16) * 0.8)(D, 3 * D)),
            "wo": _w((lambda *s: torch.randn(*s, dtype=torch.bfloat16) * 0.05)(D, D)),
        }
    _B_in = _B_setup()

    return {
        "A_u": _A_in["u"],
        "A_A_re": _A_in["A_re"],
        "A_A_im": _A_in["A_im"],
        "A_B_re": _A_in["B_re"],
        "A_B_im": _A_in["B_im"],
        "A_C_re": _A_in["C_re"],
        "A_C_im": _A_in["C_im"],
        "A_log_dt": _A_in["log_dt"],
        "A_Dskip": _A_in["Dskip"],
        "B_x": _B_in["x"],
        "B_wqkv": _B_in["wqkv"],
        "B_wo": _B_in["wo"],
        "gate_w": _w((lambda *s: torch.randn(*s, dtype=torch.bfloat16) * 0.05)(512) * 16.0),
    }

def reference(A_u, A_A_re, A_A_im, A_B_re, A_B_im, A_C_re, A_C_im, A_log_dt, A_Dskip, B_x, B_wqkv, B_wo, gate_w):
    def _A_ref(u, A_re, A_im, B_re, B_im, C_re, C_im, log_dt, Dskip):
        Bsz, L, D = u.shape
        dt = torch.exp(log_dt)[:, None]
        A = A_re + 1j * A_im
        Bc = B_re + 1j * B_im
        Cc = C_re + 1j * C_im
        logdA = dt * A
        dB = dt * Bc
        l = (lambda x, dt: x.to(dt))(torch.arange(L), A_re.dtype)
        P = torch.exp(logdA[:, :, None] * l[None, None, :])
        K = torch.einsum("dn,dnl,dn->dl", Cc, P, dB).real
        L2 = 2 * L
        Kp = _pad(K, ((0, 0), (0, L)))
        up = (lambda x, *d: x.permute(*d))(u, 0, 2, 1)
        up = _pad(up, ((0, 0), (0, 0), (0, L)))
        Kf = (lambda x, axes=(-2,-1): torch.fft.rfft2(x.float(), dim=axes))(Kp[:, None, :], axes=(-2, -1))
        Uf = (lambda x, axes=(-2,-1): torch.fft.rfft2(x.float(), dim=axes))(up[:, :, None, :], axes=(-2, -1))
        Yf = Uf * Kf[None, :, :, :]
        y = (lambda x, s, axes=(-2,-1): torch.fft.irfft2(x, s=s, dim=axes).to(torch.bfloat16))(Yf, (1, L2), axes=(-2, -1))[:, :, 0, :L]
        y = (lambda x, *d: x.permute(*d))(y, 0, 2, 1) + u * Dskip[None, None, :]
        return y

    def _B_ref(x, wqkv, wo):
        B, S, D = x.shape
        H = 32; Dh = D // H
        qkv = (lambda x, *d: x.permute(*d))((x @ wqkv).reshape(B, S, 3, H, Dh), 2, 0, 3, 1, 4)
        q, k, v = qkv[0], qkv[1], qkv[2]
        scale = Dh ** -0.5
        scores = torch.einsum("bhqd,bhkd->bhqk", q, k) * scale
        p = _softmax(scores, axis=-1)
        o = torch.einsum("bhqk,bhkd->bhqd", p, v)
        return (lambda x, *d: x.permute(*d))(o, 0, 2, 1, 3).reshape(B, S, D) @ wo

    x = A_u
    g = _sigmoid((x * gate_w).sum(-1, keepdims=True))
    a = _A_ref(x, A_A_re, A_A_im, A_B_re, A_B_im, A_C_re, A_C_im, A_log_dt, A_Dskip)
    b = _B_ref(x, B_wqkv, B_wo)
    return g * a + (1 - g) * b
```

```asm
; @launch grid=(256,1,1) block=(768,1,1) lds=163840
.amdgcn_target "amdgcn-amd-amdhsa--gfx950"
.text
.globl gated_mix__ssm_conv_s4__softmax_full_mha__prompt_kernel
.p2align 8
.type gated_mix__ssm_conv_s4__softmax_full_mha__prompt_kernel,@function
gated_mix__ssm_conv_s4__softmax_full_mha__prompt_kernel:
    s_cmp_ge_u32 s2, 256
    s_cbranch_scc1 KA_END
    s_load_dwordx16 s[4:19], s[0:1], 0
    s_load_dwordx16 s[20:35], s[0:1], 64
    v_readfirstlane_b32 s48, v0
    v_and_b32 v1, 63, v0
    s_and_b32 s49, s2, 7
    s_xor_b32 s49, s49, 3
    s_lshr_b32 s50, s2, 3
    s_lshr_b32 s48, s48, 6
    s_cmp_lt_u32 s48, 4
    s_cbranch_scc1 KA_CPF
    s_cmp_lt_u32 s48, 8
    s_cbranch_scc1 KA_LOADER
    s_setprio 3
    s_sub_u32 s54, s48, 8
    s_xor_b32 s55, s49, 4
    s_lshl_b32 s55, s55, 5
    s_add_u32 s55, s55, s50
    s_lshl_b32 s59, s55, 9
    s_lshl_b32 s60, s54, 7
    s_add_u32 s59, s59, s60
    v_lshl_add_u32 v2, v1, 1, s59
    s_lshr_b32 s59, s59, 8
    s_lshl_b32 s59, s59, 1
    v_mov_b32 v5, s59
    v_mov_b32 v8, 0
    v_mov_b32 v9, 0
    v_mov_b32 v10, 0
    v_mov_b32 v11, 0
    v_mov_b32 v12, 0
    v_mov_b32 v13, 0
    v_mov_b32 v14, 0
    v_mov_b32 v15, 0
    s_waitcnt lgkmcnt(0)
    global_load_short_d16_hi v14, v5, s[18:19]
    global_load_short_d16_hi v8, v2, s[6:7]
    global_load_short_d16_hi v9, v2, s[8:9]
    global_load_short_d16_hi v10, v2, s[10:11]
    global_load_short_d16_hi v11, v2, s[12:13]
    global_load_short_d16_hi v12, v2, s[14:15]
    global_load_short_d16_hi v13, v2, s[16:17]
    global_load_short_d16_hi v15, v5, s[20:21]
    s_branch KA_AUX0
KA_CPF:
    s_cmp_lg_u32 s48, 0
    s_cbranch_scc1 KA_CONS
    s_getpc_b64 s[56:57]
KA_PCB:
    s_sub_u32 s56, s56, KA_PCB-gated_mix__ssm_conv_s4__softmax_full_mha__prompt_kernel
    s_subb_u32 s57, s57, 0
    v_lshl_add_u32 v8, v1, 5, s50
    v_lshlrev_b32 v8, 6, v8
    v_cmp_gt_u32 vcc, KA_END-gated_mix__ssm_conv_s4__softmax_full_mha__prompt_kernel, v8
    s_mov_b64 exec, vcc
    v_mov_b32 v9, s57
    v_add_co_u32 v8, vcc, s56, v8
    v_addc_co_u32 v9, vcc, 0, v9, vcc
    global_load_dword v24, v[8:9], off
    s_mov_b64 exec, -1
KA_CPE:
    s_branch KA_CONS
KA_LOADER:
    s_add_u32 s53, s49, s50
    s_sub_u32 s54, s48, 4
    v_lshrrev_b32 v5, 3, v1
    v_and_b32 v6, 7, v1
    v_lshrrev_b32 v7, 4, v1
    v_xor_b32 v8, v6, v7
    v_lshlrev_b32 v8, 4, v8
    v_lshl_add_u32 v16, v5, 10, v8
    s_and_b32 s73, s54, 1
    s_lshl_b32 s58, s73, 6
    s_lshl_b32 s55, s50, 16
    s_lshl_b32 s60, s54, 13
    s_add_u32 s60, s60, s55
    v_xor_b32 v18, s58, v16
    v_add_u32 v18, s60, v18
    v_add_u32 v19, 32768, v18
    v_and_b32 v7, 1, v7
    v_lshlrev_b32 v7, 2, v7
    v_xor_b32 v8, v6, v7
    v_mul_u32_u24 v9, 3072, v5
    v_lshl_add_u32 v9, v8, 4, v9
    s_lshl_b32 s56, s49, 7
    s_mul_i32 s62, s54, 3
    s_add_u32 s58, s62, 0
    s_and_b32 s59, s58, 3
    s_mul_i32 s59, s59, 24576
    s_lshr_b32 s58, s58, 2
    s_lshl_b32 s58, s58, 10
    s_add_u32 s58, s58, s59
    s_add_u32 s58, s58, s56
    v_add_u32 v20, s58, v9
    s_add_u32 s58, s62, 1
    s_and_b32 s59, s58, 3
    s_mul_i32 s59, s59, 24576
    s_lshr_b32 s58, s58, 2
    s_lshl_b32 s58, s58, 10
    s_add_u32 s58, s58, s59
    s_add_u32 s58, s58, s56
    s_sub_u32 s58, s58, 1024
    v_add_u32 v21, s58, v9
    s_add_u32 s58, s62, 2
    s_and_b32 s59, s58, 3
    s_mul_i32 s59, s59, 24576
    s_lshr_b32 s58, s58, 2
    s_lshl_b32 s58, s58, 10
    s_add_u32 s58, s58, s59
    s_add_u32 s58, s58, s56
    s_sub_u32 s58, s58, 2048
    v_add_u32 v22, s58, v9
    s_lshl_b32 s61, s54, 10
    s_lshl_b32 s62, s62, 10
    s_and_b32 s64, s53, 7
    s_lshl_b32 s65, s64, 7
    s_mul_i32 s64, s64, 196608
    s_mov_b32 s38, 2097152
    s_mov_b32 s39, 0x20000
    s_mov_b32 s42, 1572864
    s_mov_b32 s43, 0x20000
    s_mov_b32 m0, s61
    s_waitcnt lgkmcnt(0)
    s_mov_b32 s36, s4
    s_and_b32 s37, s5, 0xffff
    s_mov_b32 s40, s24
    s_and_b32 s41, s25, 0xffff
    buffer_load_dwordx4 v18, s[36:39], s65 offen lds
    s_add_u32 m0, s61, 4096
    s_nop 0
    buffer_load_dwordx4 v19, s[36:39], s65 offen lds
    s_add_u32 m0, s62, 65536
    s_add_u32 s58, s64, 98304
    buffer_load_dwordx4 v20, s[40:43], s64 offen offset:0 lds
    buffer_load_dwordx4 v21, s[40:43], s64 offen offset:1024 lds
    buffer_load_dwordx4 v22, s[40:43], s64 offen offset:2048 lds
    s_cmp_lt_u32 s58, 1572864
    s_cselect_b32 s64, s58, 0
    s_mul_i32 s51, s49, 851968
    v_lshlrev_b32 v4, 4, v1
    v_lshrrev_b32 v3, 5, v1
    v_mov_b32 v164, 163584
    v_mov_b32 v165, 1
    s_mov_b32 s44, s34
    s_and_b32 s45, s35, 0xffff
    s_mov_b32 s46, 11091968
    s_mov_b32 s47, 0x20000
    v_xor_b32 v17, 64, v16
    v_add_u32 v17, 7168, v17
    s_sub_u32 s74, 4, s50
    s_and_b32 s74, s74, 7
    s_lshl_b32 s74, s74, 13
    s_lshl_b32 s58, s54, 11
    s_add_u32 s74, s74, s58
    s_mov_b32 m0, s74
    s_lshl_b32 s58, s54, 14
    s_add_u32 s58, s58, s55
    s_xor_b32 s59, s56, 512
    s_add_u32 s58, s58, s59
    buffer_load_dwordx4 v16, s[36:39], s58 offen lds
    buffer_load_dwordx4 v17, s[36:39], s58 offen offset:1024 lds
    s_add_u32 m0, s61, 8192
    s_add_u32 s65, s65, 128
    s_and_b32 s65, s65, 1023
    buffer_load_dwordx4 v18, s[36:39], s65 offen lds
    s_add_u32 m0, s62, 77824
    s_add_u32 s58, s64, 98304
    buffer_load_dwordx4 v20, s[40:43], s64 offen offset:0 lds
    buffer_load_dwordx4 v21, s[40:43], s64 offen offset:1024 lds
    buffer_load_dwordx4 v22, s[40:43], s64 offen offset:2048 lds
    s_cmp_lt_u32 s58, 1572864
    s_cselect_b32 s64, s58, 0
    s_add_u32 m0, s61, 12288
    s_nop 0
    buffer_load_dwordx4 v19, s[36:39], s65 offen lds
    s_add_u32 m0, s62, 90112
    s_add_u32 s58, s64, 98304
    buffer_load_dwordx4 v20, s[40:43], s64 offen offset:0 lds
    buffer_load_dwordx4 v21, s[40:43], s64 offen offset:1024 lds
    buffer_load_dwordx4 v22, s[40:43], s64 offen offset:2048 lds
    s_cmp_lt_u32 s58, 1572864
    s_cselect_b32 s64, s58, 0
    v_lshlrev_b32 v5, 7, v1
    s_add_u32 s67, s51, 786432
    s_mov_b32 m0, 162560
    s_lshl_b32 s58, 16, s54
    s_or_b32 exec_lo, s58, 1
    s_mov_b32 exec_hi, 0
    buffer_load_dword v163, v5, s[44:47], s67 offen sc1
    s_lshl_b32 s58, s54, 4
    s_lshl_b64 exec, 0xffff, s58
    global_load_lds_dwordx4 v4, s[28:29]
    s_mov_b64 exec, -1
    s_add_u32 m0, s61, 16384
    s_add_u32 s65, s65, 128
    s_and_b32 s65, s65, 1023
    buffer_load_dwordx4 v18, s[36:39], s65 offen lds
    s_add_u32 m0, s62, 102400
    s_add_u32 s58, s64, 98304
    buffer_load_dwordx4 v20, s[40:43], s64 offen offset:0 lds
    buffer_load_dwordx4 v21, s[40:43], s64 offen offset:1024 lds
    buffer_load_dwordx4 v22, s[40:43], s64 offen offset:2048 lds
    s_cmp_lt_u32 s58, 1572864
    s_cselect_b32 s64, s58, 0
    v_bfe_u32 v5, v1, 2, 2
    v_lshrrev_b32 v6, 4, v1
    v_bfe_u32 v7, v1, 1, 1
    v_lshl_add_u32 v6, v6, 1, v7
    v_lshrrev_b32 v7, 1, v5
    v_xor_b32 v6, v6, v7
    v_lshlrev_b32 v6, 4, v6
    v_lshl_add_u32 v6, v5, 7, v6
    v_and_b32 v7, 1, v1
    v_lshl_add_u32 v6, v7, 3, v6
    v_add_u32 v28, s74, v6
    v_xor_b32 v29, 32, v28
    v_xor_b32 v30, 64, v28
    v_xor_b32 v31, 96, v28
    s_waitcnt vmcnt(14)
    s_setprio 3
    ds_read_b64_tr_b16 v[32:33], v28 offset:0
    ds_read_b64_tr_b16 v[34:35], v29 offset:512
    ds_read_b64_tr_b16 v[36:37], v30 offset:1024
    ds_read_b64_tr_b16 v[38:39], v31 offset:1536
    s_lshl_b32 s75, s50, 13
    s_lshl_b32 s59, s54, 11
    s_add_u32 s75, s75, s59
    s_add_u32 s75, s75, s51
    s_add_u32 s75, s75, 524288
    s_waitcnt lgkmcnt(0)
    buffer_store_dwordx4 v[32:35], v4, s[44:47], s75 offen sc1
    buffer_store_dwordx4 v[36:39], v4, s[44:47], s75 offen offset:1024 sc1
    s_add_u32 m0, s61, 20480
    s_nop 0
    buffer_load_dwordx4 v19, s[36:39], s65 offen lds
    s_add_u32 m0, s62, 114688
    s_add_u32 s58, s64, 98304
    buffer_load_dwordx4 v20, s[40:43], s64 offen offset:0 lds
    buffer_load_dwordx4 v21, s[40:43], s64 offen offset:1024 lds
    buffer_load_dwordx4 v22, s[40:43], s64 offen offset:2048 lds
    s_cmp_lt_u32 s58, 1572864
    s_cselect_b32 s64, s58, 0
    v_lshrrev_b32 v10, 3, v1
    s_lshl_b32 s58, s49, 3
    v_add_u32 v10, s58, v10
    v_and_b32 v11, 7, v1
    v_bfe_u32 v12, v10, 1, 3
    v_xor_b32 v12, v12, v11
    v_lshlrev_b32 v12, 4, v12
    v_lshl_add_u32 v12, v10, 7, v12
    s_and_b32 s58, s53, 7
    s_lshl_b32 s58, s58, 7
    v_lshl_add_u32 v11, v11, 4, s58
    v_bfe_u32 v5, v1, 4, 1
    v_lshlrev_b32 v5, 16, v5
    v_and_b32 v6, 15, v1
    v_lshl_add_u32 v13, v6, 7, v5
    s_mul_i32 s71, s54, 131072
    s_lshl_b32 s58, s50, 11
    s_add_u32 s71, s71, s58
    s_add_u32 s71, s71, s51
    s_and_b32 s58, s50, 15
    s_cmp_lt_u32 s58, 3
    s_cselect_b32 s58, 0, 0x7ff00000
    v_add_u32 v13, s58, v13
    v_add_u32 v40, 0, v11
    v_and_b32 v40, 1023, v40
    v_add_u32 v40, 162560, v40
    v_add_u32 v41, 128, v11
    v_and_b32 v41, 1023, v41
    v_add_u32 v41, 162560, v41
    v_add_u32 v42, 256, v11
    v_and_b32 v42, 1023, v42
    v_add_u32 v42, 162560, v42
    v_add_u32 v43, 384, v11
    v_and_b32 v43, 1023, v43
    v_add_u32 v43, 162560, v43
    v_add_u32 v44, 512, v11
    v_and_b32 v44, 1023, v44
    v_add_u32 v44, 162560, v44
    v_add_u32 v45, 640, v11
    v_and_b32 v45, 1023, v45
    v_add_u32 v45, 162560, v45
    v_add_u32 v46, 768, v11
    v_and_b32 v46, 1023, v46
    v_add_u32 v46, 162560, v46
    v_add_u32 v47, 896, v11
    v_and_b32 v47, 1023, v47
    v_add_u32 v47, 162560, v47
    s_waitcnt vmcnt(22)
    s_barrier
    s_waitcnt vmcnt(16)
    s_barrier
    s_add_u32 m0, s61, 24576
    s_add_u32 s65, s65, 128
    s_and_b32 s65, s65, 1023
    buffer_load_dwordx4 v18, s[36:39], s65 offen lds
    s_add_u32 m0, s62, 126976
    s_add_u32 s58, s64, 98304
    buffer_load_dwordx4 v20, s[40:43], s64 offen offset:0 lds
    buffer_load_dwordx4 v21, s[40:43], s64 offen offset:1024 lds
    buffer_load_dwordx4 v22, s[40:43], s64 offen offset:2048 lds
    s_cmp_lt_u32 s58, 1572864
    s_cselect_b32 s64, s58, 0
    s_waitcnt vmcnt(16)
    s_barrier
    s_add_u32 m0, s61, 28672
    s_nop 0
    buffer_load_dwordx4 v19, s[36:39], s65 offen lds
    s_add_u32 m0, s62, 65536
    s_add_u32 s58, s64, 98304
    buffer_load_dwordx4 v20, s[40:43], s64 offen offset:0 lds
    buffer_load_dwordx4 v21, s[40:43], s64 offen offset:1024 lds
    buffer_load_dwordx4 v22, s[40:43], s64 offen offset:2048 lds
    s_cmp_lt_u32 s58, 1572864
    s_cselect_b32 s64, s58, 0
    s_waitcnt vmcnt(12)
    s_barrier
    s_add_u32 m0, s61, 32768
    s_add_u32 s65, s65, 128
    s_and_b32 s65, s65, 1023
    buffer_load_dwordx4 v18, s[36:39], s65 offen lds
    s_add_u32 m0, s62, 77824
    s_add_u32 s58, s64, 98304
    buffer_load_dwordx4 v20, s[40:43], s64 offen offset:0 lds
    buffer_load_dwordx4 v21, s[40:43], s64 offen offset:1024 lds
    buffer_load_dwordx4 v22, s[40:43], s64 offen offset:2048 lds
    s_cmp_lt_u32 s58, 1572864
    s_cselect_b32 s64, s58, 0
    s_waitcnt vmcnt(12)
    s_barrier
    s_add_u32 m0, s61, 36864
    s_nop 0
    buffer_load_dwordx4 v19, s[36:39], s65 offen lds
    s_add_u32 m0, s62, 90112
    s_add_u32 s58, s64, 98304
    buffer_load_dwordx4 v20, s[40:43], s64 offen offset:0 lds
    buffer_load_dwordx4 v21, s[40:43], s64 offen offset:1024 lds
    buffer_load_dwordx4 v22, s[40:43], s64 offen offset:2048 lds
    s_cmp_lt_u32 s58, 1572864
    s_cselect_b32 s64, s58, 0
    s_waitcnt vmcnt(12)
    s_barrier
    s_add_u32 m0, s61, 40960
    s_add_u32 s65, s65, 128
    s_and_b32 s65, s65, 1023
    buffer_load_dwordx4 v18, s[36:39], s65 offen lds
    s_add_u32 m0, s62, 102400
    s_add_u32 s58, s64, 98304
    buffer_load_dwordx4 v20, s[40:43], s64 offen offset:0 lds
    buffer_load_dwordx4 v21, s[40:43], s64 offen offset:1024 lds
    buffer_load_dwordx4 v22, s[40:43], s64 offen offset:2048 lds
    s_cmp_lt_u32 s58, 1572864
    s_cselect_b32 s64, s58, 0
    s_waitcnt vmcnt(12)
    s_barrier
    s_add_u32 m0, s61, 45056
    s_nop 0
    buffer_load_dwordx4 v19, s[36:39], s65 offen lds
    s_add_u32 m0, s62, 114688
    s_add_u32 s58, s64, 98304
    buffer_load_dwordx4 v20, s[40:43], s64 offen offset:0 lds
    buffer_load_dwordx4 v21, s[40:43], s64 offen offset:1024 lds
    buffer_load_dwordx4 v22, s[40:43], s64 offen offset:2048 lds
    s_cmp_lt_u32 s58, 1572864
    s_cselect_b32 s64, s58, 0
    s_waitcnt vmcnt(12)
    s_barrier
    s_add_u32 m0, s61, 49152
    s_add_u32 s65, s65, 128
    s_and_b32 s65, s65, 1023
    buffer_load_dwordx4 v18, s[36:39], s65 offen lds
    s_add_u32 m0, s62, 126976
    s_add_u32 s58, s64, 98304
    buffer_load_dwordx4 v20, s[40:43], s64 offen offset:0 lds
    buffer_load_dwordx4 v21, s[40:43], s64 offen offset:1024 lds
    buffer_load_dwordx4 v22, s[40:43], s64 offen offset:2048 lds
    s_cmp_lt_u32 s58, 1572864
    s_cselect_b32 s64, s58, 0
    s_waitcnt vmcnt(12)
    s_barrier
    s_add_u32 m0, s61, 53248
    s_nop 0
    buffer_load_dwordx4 v19, s[36:39], s65 offen lds
    s_add_u32 m0, s62, 65536
    s_add_u32 s58, s64, 98304
    buffer_load_dwordx4 v20, s[40:43], s64 offen offset:0 lds
    buffer_load_dwordx4 v21, s[40:43], s64 offen offset:1024 lds
    buffer_load_dwordx4 v22, s[40:43], s64 offen offset:2048 lds
    s_cmp_lt_u32 s58, 1572864
    s_cselect_b32 s64, s58, 0
    s_waitcnt vmcnt(12)
    s_barrier
    s_add_u32 m0, s61, 57344
    s_add_u32 s65, s65, 128
    s_and_b32 s65, s65, 1023
    buffer_load_dwordx4 v18, s[36:39], s65 offen lds
    s_add_u32 m0, s62, 77824
    s_add_u32 s58, s64, 98304
    buffer_load_dwordx4 v20, s[40:43], s64 offen offset:0 lds
    buffer_load_dwordx4 v21, s[40:43], s64 offen offset:1024 lds
    buffer_load_dwordx4 v22, s[40:43], s64 offen offset:2048 lds
    s_cmp_lt_u32 s58, 1572864
    s_cselect_b32 s64, s58, 0
    s_waitcnt vmcnt(12)
    s_barrier
    s_add_u32 m0, s61, 61440
    s_nop 0
    buffer_load_dwordx4 v19, s[36:39], s65 offen lds
    s_add_u32 m0, s62, 90112
    s_add_u32 s58, s64, 98304
    buffer_load_dwordx4 v20, s[40:43], s64 offen offset:0 lds
    buffer_load_dwordx4 v21, s[40:43], s64 offen offset:1024 lds
    buffer_load_dwordx4 v22, s[40:43], s64 offen offset:2048 lds
    s_cmp_lt_u32 s58, 1572864
    s_cselect_b32 s64, s58, 0
    s_waitcnt vmcnt(12)
    s_barrier
    s_add_u32 m0, s62, 102400
    s_add_u32 s58, s64, 98304
    buffer_load_dwordx4 v20, s[40:43], s64 offen offset:0 lds
    buffer_load_dwordx4 v21, s[40:43], s64 offen offset:1024 lds
    buffer_load_dwordx4 v22, s[40:43], s64 offen offset:2048 lds
    s_cmp_lt_u32 s58, 1572864
    s_cselect_b32 s64, s58, 0
    s_waitcnt vmcnt(11)
    s_barrier
    s_cmp_eq_u32 s54, 3
    s_cbranch_scc1 KA_LG
    s_waitcnt vmcnt(7)
    s_barrier
    s_waitcnt vmcnt(3)
    s_barrier
    s_waitcnt vmcnt(0)
    s_barrier
    s_cmp_eq_u32 s54, 2
    s_cbranch_scc1 KA_LZ
    s_cmp_eq_u32 s54, 1
    s_cbranch_scc1 KA_LP
KA_ATT:
    s_setprio 0
    s_and_b32 s54, s48, 3
    s_lshr_b32 s55, s48, 2
    s_mul_i32 s57, s54, 131072
    s_add_u32 s57, s57, s51
    s_lshl_b32 s58, s55, 15
    s_add_u32 s58, s58, s57
    s_add_u32 s58, s58, 4096
    s_add_u32 s58, s34, s58
    s_addc_u32 s59, s35, 0
    s_lshl_b32 s56, s50, 16
    s_lshl_b32 s60, s49, 13
    s_add_u32 s56, s56, s60
    s_add_u32 s56, s56, 6897664
    s_lshl_b32 s60, s48, 10
    s_add_u32 s56, s56, s60
    v_mov_b32 v24, 0xdddd
    s_mov_b32 s62, 0xffff
    s_mov_b32 s63, 0xffff
    v_and_b32 v2, 27, v1
    v_and_b32 v6, 15, v1
    v_lshl_add_u32 v6, v3, 4, v6
    v_lshlrev_b32 v6, 4, v6
    v_add_u32 v6, 64512, v6
    v_cmp_eq_u32 vcc, 16, v2
    v_mov_b32 v7, 0x3f803f80
    v_lshlrev_b32 v157, 3, v1
    v_cndmask_b32 v7, 0, v7, vcc
    s_lshl_b32 s60, s54, 11
    s_add_u32 s60, s60, 114688
    v_add_u32 v5, s60, v4
    s_mov_b32 s64, 0xc0
    v_mov_b32 v104, v7
    v_mov_b32 v105, v7
    v_mov_b32 v106, v7
    v_mov_b32 v107, v7
    v_mov_b32 v108, v7
    v_mov_b32 v109, v7
    v_mov_b32 v110, v7
    v_mov_b32 v111, v7
    v_mov_b32 v116, v7
    v_mov_b32 v117, v7
    v_mov_b32 v118, v7
    v_mov_b32 v119, v7
    v_mov_b32 v120, v7
    v_mov_b32 v121, v7
    v_mov_b32 v122, v7
    v_mov_b32 v123, v7
    v_mov_b32 v128, v7
    v_mov_b32 v129, v7
    v_mov_b32 v130, v7
    v_mov_b32 v131, v7
    v_mov_b32 v132, v7
    v_mov_b32 v133, v7
    v_mov_b32 v134, v7
    v_mov_b32 v135, v7
    v_mov_b32 v140, v7
    v_mov_b32 v141, v7
    v_mov_b32 v142, v7
    v_mov_b32 v143, v7
    v_mov_b32 v144, v7
    v_mov_b32 v145, v7
    v_mov_b32 v146, v7
    v_mov_b32 v147, v7
    v_mov_b32 v36, 0
    v_mov_b32 v37, 0
    v_mov_b32 v38, 0
    v_mov_b32 v39, 0
    v_mov_b32 v40, 0
    v_mov_b32 v41, 0
    v_mov_b32 v42, 0
    v_mov_b32 v43, 0
    v_mov_b32 v44, 0
    v_mov_b32 v45, 0
    v_mov_b32 v46, 0
    v_mov_b32 v47, 0
    v_mov_b32 v48, 0
    v_mov_b32 v49, 0
    v_mov_b32 v50, 0
    v_mov_b32 v51, 0
    v_mov_b32 v52, 0
    v_mov_b32 v53, 0
    v_mov_b32 v54, 0
    v_mov_b32 v55, 0
    v_mov_b32 v56, 0
    v_mov_b32 v57, 0
    v_mov_b32 v58, 0
    v_mov_b32 v59, 0
    v_mov_b32 v60, 0
    v_mov_b32 v61, 0
    v_mov_b32 v62, 0
    v_mov_b32 v63, 0
    v_mov_b32 v64, 0
    v_mov_b32 v65, 0
    v_mov_b32 v66, 0
    v_mov_b32 v67, 0
    v_mov_b32 v92, 0
    v_mov_b32 v93, 0
    v_mov_b32 v94, 0
    v_mov_b32 v95, 0
    v_mov_b32 v96, 0
    v_mov_b32 v97, 0
    v_mov_b32 v98, 0
    v_mov_b32 v99, 0
    s_mul_i32 s60, s48, 2304
    s_add_u32 s60, s60, 0
    s_xor_b32 s61, s48, 4
    s_mul_i32 s61, s61, 2304
    s_add_u32 s61, s61, 0
    v_add_u32 v16, s60, v4
    v_add_u32 v17, s61, v4
    v_lshl_add_u32 v18, v1, 2, s60
    v_lshl_add_u32 v19, v1, 2, s61
    s_lshl_b32 s60, s54, 2
    v_add_u32 v20, s60, v164
    v_mov_b32 v21, 0x17800000
    v_mov_b32 v22, 0x67800000
    v_mov_b32 v23, 0x7f7fffff
    s_lshl_b32 s74, s50, 11
    s_add_u32 s74, s74, 6832128
    v_lshlrev_b32 v154, 2, s49
    s_mov_b32 s65, 0
    s_cmp_eq_u32 s55, 0
    s_cbranch_scc1 KA_AT1
    s_mov_b32 s77, 1048576
    s_branch KA_W1F
KA_W1:
    s_sleep 2
KA_W1F:
    ds_read_b32 v166, v164 offset:108
    s_sub_u32 s77, s77, 1
    s_cbranch_scc1 KA_E2
    s_waitcnt lgkmcnt(0)
    v_readfirstlane_b32 s52, v166
    s_cmp_lt_u32 s52, 1
    s_cbranch_scc1 KA_W1
KA_E2:
KA_AT1:
    v_mov_b32 v153, s52
    s_mov_b32 s77, 1048576
    s_branch KA_W3F
KA_W3:
    s_sleep 4
KA_W3F:
    ds_read_b32 v166, v164 offset:104
    s_sub_u32 s77, s77, 1
    s_cbranch_scc1 KA_E4
    s_waitcnt lgkmcnt(0)
    v_readfirstlane_b32 s76, v166
    s_cmp_lt_u32 s76, 4
    s_cbranch_scc1 KA_W3
KA_E4:
    ds_read_b128 v[8:11], v5
    ds_read_b128 v[12:15], v5 offset:1024
    s_cmp_lg_u32 s48, 4
    s_cbranch_scc1 KA_AT2
    s_getreg_b32 s66, hwreg(HW_REG_XCC_ID)
    s_and_b32 s66, s66, 15
    s_add_u32 s66, s66, 1
    s_lshl_b32 s66, s66, 1
    s_xor_b32 s66, s66, s52
    s_add_u32 s67, s51, 786944
    v_lshlrev_b32 v156, 7, v1
    s_lshl_b32 s60, s50, 2
    v_add_u32 v156, s60, v156
    s_mov_b32 s77, 1048576
    s_branch KA_W5F
KA_W5:
    s_sleep 1
KA_W5F:
    ds_read_b32 v166, v164 offset:176
    s_sub_u32 s77, s77, 1
    s_cbranch_scc1 KA_E6
    s_waitcnt lgkmcnt(0)
    v_readfirstlane_b32 s76, v166
    s_cmp_lt_u32 s76, 4
    s_cbranch_scc1 KA_W5
KA_E6:
    s_mov_b32 s69, 64
KA_GF7:
    buffer_load_dwordx2 v[158:159], v157, s[44:47], s67 offen offset:0 sc1
    s_waitcnt vmcnt(0)
    v_cmp_ne_u32 vcc, s66, v158
    v_cmp_ne_u32 s[70:71], s66, v159
    s_or_b64 vcc, vcc, s[70:71]
    s_cbranch_scc0 KA_GD9
    s_sub_u32 s69, s69, 1
    s_cbranch_scc0 KA_GF7
    buffer_wbl2 sc1
    s_waitcnt vmcnt(0)
    v_mov_b32 v155, s52
    s_mov_b64 exec, 15
    buffer_store_dword v155, v156, s[44:47], s67 offen offset:1024 sc1
    s_mov_b64 exec, -1
KA_GS8N:
    s_mov_b32 s69, 20000
KA_GS8:
    buffer_load_dwordx2 v[158:159], v157, s[44:47], s67 offen offset:0 sc1
    buffer_load_dwordx2 v[160:161], v157, s[44:47], s67 offen offset:1024 sc1
    s_waitcnt vmcnt(0)
    v_cmp_ne_u32 vcc, s66, v158
    v_cmp_ne_u32 s[70:71], s52, v160
    s_and_b64 vcc, vcc, s[70:71]
    v_cmp_ne_u32 s[70:71], s66, v159
    v_cmp_ne_u32 s[72:73], s52, v161
    s_and_b64 s[70:71], s[70:71], s[72:73]
    s_or_b64 vcc, vcc, s[70:71]
    s_cbranch_scc0 KA_GD9A
    s_sleep 8
    s_sub_u32 s69, s69, 1
    s_cbranch_scc0 KA_GS8
KA_GD9A:
    buffer_inv sc1
    s_waitcnt vmcnt(0)
KA_GD9:
    s_mov_b64 exec, 1
    ds_add_u32 v164, v165 offset:164
    s_mov_b64 exec, -1
    s_branch KA_AT3
KA_AT2:
    s_waitcnt vmcnt(0)
    s_cmp_lg_u32 s48, 7
    s_cbranch_scc1 KA_NOGF
    s_mov_b64 exec, 1
    ds_add_u32 v164, v165 offset:144
    s_mov_b64 exec, -1
KA_NOGF:
    s_mov_b32 s77, 1048576
    s_branch KA_W10F
KA_W10:
    s_sleep 2
KA_W10F:
    ds_read_b32 v166, v164 offset:164
    s_sub_u32 s77, s77, 1
    s_cbranch_scc1 KA_E11
    s_waitcnt lgkmcnt(0)
    v_readfirstlane_b32 s76, v166
    s_cmp_lt_u32 s76, 1
    s_cbranch_scc1 KA_W10
KA_E11:
KA_AT3:
    global_load_dwordx4 v[100:103], v4, s[58:59] offset:-4096
    s_mov_b64 exec, s[62:63]
    global_load_dwordx4 v[104:107], v6, s[58:59] offset:-3072
    global_load_dwordx4 v[108:111], v6, s[58:59] offset:-2560
    s_mov_b64 exec, -1
    global_load_dwordx4 v[112:115], v4, s[58:59] offset:-3072
    s_mov_b64 exec, s[62:63]
    global_load_dwordx4 v[116:119], v6, s[58:59] offset:-2048
    global_load_dwordx4 v[120:123], v6, s[58:59] offset:-1536
    s_mov_b64 exec, -1
    global_load_dwordx4 v[124:127], v4, s[58:59] offset:-2048
    s_mov_b64 exec, s[62:63]
    global_load_dwordx4 v[128:131], v6, s[58:59] offset:-1024
    global_load_dwordx4 v[132:135], v6, s[58:59] offset:-512
    s_mov_b64 exec, -1
    global_load_dwordx4 v[136:139], v4, s[58:59] offset:-1024
    s_setprio 2
    s_waitcnt vmcnt(9) lgkmcnt(0)
    v_mfma_f32_32x32x16_bf16 v[68:83], v[100:103], v[8:11], 0
    s_nop 11
.p2align 6
KA_LOOP:
    v_exp_f32 v68, v68
    v_exp_f32 v69, v69
    v_smfmac_f32_32x32x32_bf16 v[52:67], v[144:147], v[92:99], v24
    s_mov_b64 exec, s[62:63]
    global_load_dwordx4 v[140:143], v6, s[58:59] offset:0
    global_load_dwordx4 v[144:147], v6, s[58:59] offset:512
    s_mov_b64 exec, -1
    v_exp_f32 v70, v70
    v_exp_f32 v71, v71
    v_exp_f32 v72, v72
    v_mfma_f32_32x32x16_bf16 v[84:99], v[100:103], v[12:15], 0
    global_load_dwordx4 v[100:103], v4, s[58:59] offset:0
    v_exp_f32 v73, v73
    v_exp_f32 v74, v74
    v_exp_f32 v75, v75
    v_exp_f32 v76, v76
    v_exp_f32 v77, v77
    v_exp_f32 v78, v78
    s_waitcnt vmcnt(9)
    v_smfmac_f32_32x32x32_bf16 v[36:51], v[104:107], v[68:75], v24
    v_exp_f32 v79, v79
    v_exp_f32 v80, v80
    v_exp_f32 v81, v81
    v_exp_f32 v82, v82
    v_exp_f32 v83, v83
    v_exp_f32 v84, v84
    v_exp_f32 v85, v85
    v_smfmac_f32_32x32x32_bf16 v[36:51], v[108:111], v[76:83], v24
    v_exp_f32 v86, v86
    v_exp_f32 v87, v87
    v_exp_f32 v88, v88
    v_mfma_f32_32x32x16_bf16 v[68:83], v[112:115], v[8:11], 0
    v_exp_f32 v89, v89
    v_exp_f32 v90, v90
    v_exp_f32 v91, v91
    v_exp_f32 v92, v92
    v_exp_f32 v93, v93
    v_exp_f32 v94, v94
    v_smfmac_f32_32x32x32_bf16 v[52:67], v[104:107], v[84:91], v24
    v_exp_f32 v95, v95
    v_exp_f32 v96, v96
    v_exp_f32 v97, v97
    v_exp_f32 v98, v98
    v_exp_f32 v99, v99
    v_exp_f32 v68, v68
    v_exp_f32 v69, v69
    v_smfmac_f32_32x32x32_bf16 v[52:67], v[108:111], v[92:99], v24
    s_mov_b64 exec, s[62:63]
    global_load_dwordx4 v[104:107], v6, s[58:59] offset:1024
    global_load_dwordx4 v[108:111], v6, s[58:59] offset:1536
    s_mov_b64 exec, -1
    v_exp_f32 v70, v70
    v_exp_f32 v71, v71
    v_exp_f32 v72, v72
    v_mfma_f32_32x32x16_bf16 v[84:99], v[112:115], v[12:15], 0
    global_load_dwordx4 v[112:115], v4, s[58:59] offset:1024
    v_exp_f32 v73, v73
    v_exp_f32 v74, v74
    v_exp_f32 v75, v75
    v_exp_f32 v76, v76
    v_exp_f32 v77, v77
    v_exp_f32 v78, v78
    s_waitcnt vmcnt(9)
    v_smfmac_f32_32x32x32_bf16 v[36:51], v[116:119], v[68:75], v24
    v_exp_f32 v79, v79
    v_exp_f32 v80, v80
    v_exp_f32 v81, v81
    v_exp_f32 v82, v82
    v_exp_f32 v83, v83
    v_exp_f32 v84, v84
    v_exp_f32 v85, v85
    v_smfmac_f32_32x32x32_bf16 v[36:51], v[120:123], v[76:83], v24
    v_exp_f32 v86, v86
    v_exp_f32 v87, v87
    v_exp_f32 v88, v88
    v_mfma_f32_32x32x16_bf16 v[68:83], v[124:127], v[8:11], 0
    v_exp_f32 v89, v89
    v_exp_f32 v90, v90
    v_exp_f32 v91, v91
    v_exp_f32 v92, v92
    v_exp_f32 v93, v93
    v_exp_f32 v94, v94
    v_smfmac_f32_32x32x32_bf16 v[52:67], v[116:119], v[84:91], v24
    v_exp_f32 v95, v95
    v_exp_f32 v96, v96
    v_exp_f32 v97, v97
    v_exp_f32 v98, v98
    v_exp_f32 v99, v99
    v_exp_f32 v68, v68
    v_exp_f32 v69, v69
    v_smfmac_f32_32x32x32_bf16 v[52:67], v[120:123], v[92:99], v24
    s_mov_b64 exec, s[62:63]
    global_load_dwordx4 v[116:119], v6, s[58:59] offset:2048
    global_load_dwordx4 v[120:123], v6, s[58:59] offset:2560
    s_mov_b64 exec, -1
    v_exp_f32 v70, v70
    v_exp_f32 v71, v71
    v_exp_f32 v72, v72
    v_mfma_f32_32x32x16_bf16 v[84:99], v[124:127], v[12:15], 0
    global_load_dwordx4 v[124:127], v4, s[58:59] offset:2048
    v_exp_f32 v73, v73
    v_exp_f32 v74, v74
    v_exp_f32 v75, v75
    v_exp_f32 v76, v76
    v_exp_f32 v77, v77
    v_exp_f32 v78, v78
    s_waitcnt vmcnt(9)
    v_smfmac_f32_32x32x32_bf16 v[36:51], v[128:131], v[68:75], v24
    v_exp_f32 v79, v79
    v_exp_f32 v80, v80
    v_exp_f32 v81, v81
    v_exp_f32 v82, v82
    v_exp_f32 v83, v83
    v_exp_f32 v84, v84
    v_exp_f32 v85, v85
    v_smfmac_f32_32x32x32_bf16 v[36:51], v[132:135], v[76:83], v24
    v_exp_f32 v86, v86
    v_exp_f32 v87, v87
    v_exp_f32 v88, v88
    v_mfma_f32_32x32x16_bf16 v[68:83], v[136:139], v[8:11], 0
    v_exp_f32 v89, v89
    v_exp_f32 v90, v90
    v_exp_f32 v91, v91
    v_exp_f32 v92, v92
    v_exp_f32 v93, v93
    v_exp_f32 v94, v94
    v_smfmac_f32_32x32x32_bf16 v[52:67], v[128:131], v[84:91], v24
    v_exp_f32 v95, v95
    v_exp_f32 v96, v96
    v_exp_f32 v97, v97
    v_exp_f32 v98, v98
    v_exp_f32 v99, v99
    s_bitcmp1_b32 s64, s65
    s_cbranch_scc1 KA_SPECIAL
KA_BODY:
    v_exp_f32 v68, v68
    v_exp_f32 v69, v69
    v_smfmac_f32_32x32x32_bf16 v[52:67], v[132:135], v[92:99], v24
    s_mov_b64 exec, s[62:63]
    global_load_dwordx4 v[128:131], v6, s[58:59] offset:3072
    global_load_dwordx4 v[132:135], v6, s[58:59] offset:3584
    s_mov_b64 exec, -1
    v_exp_f32 v70, v70
    v_exp_f32 v71, v71
    v_exp_f32 v72, v72
    v_mfma_f32_32x32x16_bf16 v[84:99], v[136:139], v[12:15], 0
    global_load_dwordx4 v[136:139], v4, s[58:59] offset:3072
    v_exp_f32 v73, v73
    v_exp_f32 v74, v74
    v_exp_f32 v75, v75
    v_exp_f32 v76, v76
    v_exp_f32 v77, v77
    v_exp_f32 v78, v78
    s_waitcnt vmcnt(9)
    v_smfmac_f32_32x32x32_bf16 v[36:51], v[140:143], v[68:75], v24
    v_exp_f32 v79, v79
    v_exp_f32 v80, v80
    v_exp_f32 v81, v81
    v_exp_f32 v82, v82
    v_exp_f32 v83, v83
    v_exp_f32 v84, v84
    v_exp_f32 v85, v85
    v_smfmac_f32_32x32x32_bf16 v[36:51], v[144:147], v[76:83], v24
    v_exp_f32 v86, v86
    v_exp_f32 v87, v87
    v_exp_f32 v88, v88
    v_mfma_f32_32x32x16_bf16 v[68:83], v[100:103], v[8:11], 0
    v_exp_f32 v89, v89
    v_exp_f32 v90, v90
    v_exp_f32 v91, v91
    v_exp_f32 v92, v92
    v_exp_f32 v93, v93
    v_exp_f32 v94, v94
    v_smfmac_f32_32x32x32_bf16 v[52:67], v[140:143], v[84:91], v24
    v_exp_f32 v95, v95
    v_exp_f32 v96, v96
    s_add_u32 s58, s58, 4096
    s_addc_u32 s59, s59, 0
    s_add_u32 s65, s65, 1
    s_cmp_lt_u32 s65, 8
    v_exp_f32 v97, v97
    v_exp_f32 v98, v98
    v_exp_f32 v99, v99
    s_cbranch_scc1 KA_LOOP
    s_nop 0
    v_smfmac_f32_32x32x32_bf16 v[52:67], v[144:147], v[92:99], v24
    s_cmp_eq_u32 s55, 0
    s_cbranch_scc1 KA_XA
    ds_write_b128 v16, v[36:39]
    ds_write_b128 v16, v[40:43] offset:1024
    ds_write_b32 v18, v44 offset:2048
    s_mov_b64 exec, 1
    ds_add_u32 v20, v165 offset:128
    ds_add_u32 v164, v165 offset:148
    s_mov_b64 exec, -1
    s_mov_b32 s77, 1048576
    s_branch KA_W12F
KA_W12:
    s_sleep 1
KA_W12F:
    ds_read_b32 v166, v20 offset:128
    s_sub_u32 s77, s77, 1
    s_cbranch_scc1 KA_E13
    s_waitcnt lgkmcnt(0)
    v_readfirstlane_b32 s76, v166
    s_cmp_lt_u32 s76, 2
    s_cbranch_scc1 KA_W12
KA_E13:
    ds_read_b32 v44, v19 offset:2048
    ds_read_b128 v[36:39], v17
    ds_read_b128 v[40:43], v17 offset:1024
    s_branch KA_XJ
KA_XA:
    s_nop 9
    ds_write_b128 v16, v[52:55]
    ds_write_b128 v16, v[56:59] offset:1024
    ds_write_b32 v18, v60 offset:2048
    s_mov_b64 exec, 1
    ds_add_u32 v20, v165 offset:128
    ds_add_u32 v164, v165 offset:148
    s_mov_b64 exec, -1
    s_mov_b32 s77, 1048576
    s_branch KA_W14F
KA_W14:
    s_sleep 1
KA_W14F:
    ds_read_b32 v166, v20 offset:128
    s_sub_u32 s77, s77, 1
    s_cbranch_scc1 KA_E15
    s_waitcnt lgkmcnt(0)
    v_readfirstlane_b32 s76, v166
    s_cmp_lt_u32 s76, 2
    s_cbranch_scc1 KA_W14
KA_E15:
    ds_read_b32 v60, v19 offset:2048
    ds_read_b128 v[52:55], v17
    ds_read_b128 v[56:59], v17 offset:1024
KA_XJ:
    s_waitcnt lgkmcnt(2)
    v_add_f32 v68, v44, v60
    s_waitcnt lgkmcnt(0)
    v_rcp_f32 v69, v68
    v_add_f32 v36, v36, v52
    v_add_f32 v37, v37, v53
    v_add_f32 v38, v38, v54
    v_add_f32 v39, v39, v55
    v_add_f32 v40, v40, v56
    v_add_f32 v41, v41, v57
    v_add_f32 v42, v42, v58
    v_add_f32 v43, v43, v59
    v_cmp_nge_f32 vcc, v68, v21
    v_cmp_nle_f32 s[68:69], v68, v22
    v_mul_f32 v36, v36, v69
    v_mul_f32 v37, v37, v69
    v_mul_f32 v38, v38, v69
    v_mul_f32 v39, v39, v69
    v_mul_f32 v40, v40, v69
    v_mul_f32 v41, v41, v69
    v_mul_f32 v42, v42, v69
    v_mul_f32 v43, v43, v69
    v_add_f32 v70, |v36|, |v37|
    v_add_f32 v71, |v38|, |v39|
    v_add_f32 v72, |v40|, |v41|
    v_add_f32 v73, |v42|, |v43|
    v_add_f32 v70, v70, v71
    v_add_f32 v72, v72, v73
    v_add_f32 v70, v70, v72
    s_or_b64 vcc, vcc, s[68:69]
    v_cmp_nle_f32 s[68:69], v70, v23
    v_cvt_pk_bf16_f32 v28, v36, v37
    v_cvt_pk_bf16_f32 v29, v38, v39
    v_cvt_pk_bf16_f32 v30, v40, v41
    v_cvt_pk_bf16_f32 v31, v42, v43
    s_or_b64 vcc, vcc, s[68:69]
    s_cbranch_scc1 KA_SLOW
KA_FIN:
    buffer_store_dwordx4 v[28:31], v4, s[44:47], s56 offen sc1
    s_waitcnt vmcnt(0)
    s_mov_b64 exec, 1
    ds_add_rtn_u32 v166, v164, v165 offset:160
    s_waitcnt lgkmcnt(0)
    v_readfirstlane_b32 s76, v166
    s_cmp_lg_u32 s76, 7
    s_cbranch_scc1 KA_NLAST
    buffer_atomic_swap v153, v154, s[44:47], s74 offen sc1
KA_NLAST:
    s_cmp_lg_u32 s76, 0
    s_cbranch_scc1 KA_NFIRST
    s_mov_b64 exec, 0xff
    s_lshl_b32 s72, s49, 2
    s_and_b32 s73, s50, 3
    s_add_u32 s72, s72, s73
    s_lshl_b32 s72, s72, 11
    s_add_u32 s72, s72, 6832128
    v_lshlrev_b32 v16, 2, v1
    s_mov_b32 s69, 20000
    v_mov_b32 v24, 0
    buffer_atomic_or v24, v16, s[44:47], s72 offen sc0 sc1
KA_WP:
    s_sleep 2
    v_mov_b32 v25, 0
    buffer_atomic_or v25, v16, s[44:47], s72 offen sc0 sc1
    s_waitcnt vmcnt(1)
    v_cmp_eq_u32 vcc, s52, v24
    s_nop 1
    v_mov_b32 v19, vcc_lo
    ds_or_b32 v164, v19 offset:152
    s_cmp_eq_u32 vcc_lo, 0xff
    s_cbranch_scc1 KA_NFIRST
    s_sleep 2
    v_mov_b32 v24, 0
    buffer_atomic_or v24, v16, s[44:47], s72 offen sc0 sc1
    s_waitcnt vmcnt(1)
    v_cmp_eq_u32 vcc, s52, v25
    s_nop 1
    v_mov_b32 v19, vcc_lo
    ds_or_b32 v164, v19 offset:152
    s_cmp_eq_u32 vcc_lo, 0xff
    s_cbranch_scc1 KA_NFIRST
    s_sub_u32 s69, s69, 1
    s_cbranch_scc0 KA_WP
KA_NFIRST:
    s_endpgm
KA_SPECIAL:
    s_mov_b64 exec, 1
    ds_add_u32 v164, v165 offset:96
    s_mov_b64 exec, -1
    s_setprio 1
    s_cmp_eq_u32 s65, 6
    s_cbranch_scc1 KA_BODY
    s_setprio 0
    s_branch KA_BODY
KA_SLOW:
    s_cmp_eq_u32 s55, 0
    s_cbranch_scc1 KA_SLQ
    v_mov_b32 v8, v12
    v_mov_b32 v9, v13
    v_mov_b32 v10, v14
    v_mov_b32 v11, v15
KA_SLQ:
    s_waitcnt vmcnt(0)
    v_mov_b32 v84, 0xff800000
    s_add_u32 s58, s34, s57
    s_addc_u32 s59, s35, 0
    s_mov_b32 s65, 0
KA_MAXL:
    global_load_dwordx4 v[100:103], v4, s[58:59] offset:0
    s_add_u32 s58, s58, 1024
    s_addc_u32 s59, s59, 0
    s_add_u32 s65, s65, 1
    s_waitcnt vmcnt(0)
    v_mfma_f32_32x32x16_bf16 v[68:83], v[100:103], v[8:11], 0
    s_nop 15
    v_max3_f32 v84, v68, v69, v84
    v_max3_f32 v84, v70, v71, v84
    v_max3_f32 v84, v72, v73, v84
    v_max3_f32 v84, v74, v75, v84
    v_max3_f32 v84, v76, v77, v84
    v_max3_f32 v84, v78, v79, v84
    v_max3_f32 v84, v80, v81, v84
    v_max3_f32 v84, v82, v83, v84
    s_cmp_lt_u32 s65, 64
    s_cbranch_scc1 KA_MAXL
    v_mov_b32 v85, v84
    s_nop 1
    v_permlane32_swap_b32 v84, v85
    v_max_f32 v84, v84, v85
    v_mov_b32 v36, 0
    v_mov_b32 v37, 0
    v_mov_b32 v38, 0
    v_mov_b32 v39, 0
    v_mov_b32 v40, 0
    v_mov_b32 v41, 0
    v_mov_b32 v42, 0
    v_mov_b32 v43, 0
    v_mov_b32 v44, 0
    v_mov_b32 v45, 0
    v_mov_b32 v46, 0
    v_mov_b32 v47, 0
    v_mov_b32 v48, 0
    v_mov_b32 v49, 0
    v_mov_b32 v50, 0
    v_mov_b32 v51, 0
    s_add_u32 s58, s34, s57
    s_addc_u32 s59, s35, 0
    s_mov_b32 s65, 0
KA_SLOWL:
    global_load_dwordx4 v[100:103], v4, s[58:59] offset:0
    s_mov_b64 exec, s[62:63]
    global_load_dwordx4 v[104:107], v6, s[58:59] offset:1024
    global_load_dwordx4 v[108:111], v6, s[58:59] offset:1536
    s_mov_b64 exec, -1
    s_add_u32 s58, s58, 1024
    s_addc_u32 s59, s59, 0
    s_add_u32 s65, s65, 1
    s_waitcnt vmcnt(0)
    v_mfma_f32_32x32x16_bf16 v[68:83], v[100:103], v[8:11], 0
    s_nop 15
    v_sub_f32 v68, v68, v84
    v_sub_f32 v69, v69, v84
    v_sub_f32 v70, v70, v84
    v_sub_f32 v71, v71, v84
    v_sub_f32 v72, v72, v84
    v_sub_f32 v73, v73, v84
    v_sub_f32 v74, v74, v84
    v_sub_f32 v75, v75, v84
    v_sub_f32 v76, v76, v84
    v_sub_f32 v77, v77, v84
    v_sub_f32 v78, v78, v84
    v_sub_f32 v79, v79, v84
    v_sub_f32 v80, v80, v84
    v_sub_f32 v81, v81, v84
    v_sub_f32 v82, v82, v84
    v_sub_f32 v83, v83, v84
    v_exp_f32 v68, v68
    v_exp_f32 v69, v69
    v_exp_f32 v70, v70
    v_exp_f32 v71, v71
    v_exp_f32 v72, v72
    v_exp_f32 v73, v73
    v_exp_f32 v74, v74
    v_exp_f32 v75, v75
    v_exp_f32 v76, v76
    v_exp_f32 v77, v77
    v_exp_f32 v78, v78
    v_exp_f32 v79, v79
    v_exp_f32 v80, v80
    v_exp_f32 v81, v81
    v_exp_f32 v82, v82
    v_exp_f32 v83, v83
    s_nop 1
    v_smfmac_f32_32x32x32_bf16 v[36:51], v[104:107], v[68:75], v24
    v_smfmac_f32_32x32x32_bf16 v[36:51], v[108:111], v[76:83], v24
    s_nop 7
    s_cmp_lt_u32 s65, 64
    s_cbranch_scc1 KA_SLOWL
    s_nop 15
    v_rcp_f32 v68, v44
    s_nop 0
    v_mul_f32 v36, v36, v68
    v_mul_f32 v37, v37, v68
    v_mul_f32 v38, v38, v68
    v_mul_f32 v39, v39, v68
    v_mul_f32 v40, v40, v68
    v_mul_f32 v41, v41, v68
    v_mul_f32 v42, v42, v68
    v_mul_f32 v43, v43, v68
    v_cvt_pk_bf16_f32 v28, v36, v37
    v_cvt_pk_bf16_f32 v29, v38, v39
    v_cvt_pk_bf16_f32 v30, v40, v41
    v_cvt_pk_bf16_f32 v31, v42, v43
    s_branch KA_FIN
KA_LZ:
    v_mov_b32 v8, 0
    v_lshlrev_b32 v5, 2, v1
    v_add_u32 v5, 22788, v5
    s_mov_b64 exec, 0x7fff
    ds_write_b32 v5, v8 offset:0
    ds_write_b32 v5, v8 offset:4160
    ds_write_b32 v5, v8 offset:8384
    ds_write_b32 v5, v8 offset:12544
    s_mov_b64 exec, 0x7ffe
    ds_write_b32 v5, v8 offset:16768
    ds_write_b32 v5, v8 offset:20928
    ds_write_b32 v5, v8 offset:25152
    ds_write_b32 v5, v8 offset:29312
    s_mov_b64 exec, 1
    ds_add_u32 v164, v165 offset:180
    ds_add_u32 v164, v165 offset:184
    s_mov_b64 exec, -1
KA_LP:
    s_setprio 0
    s_mul_i32 s58, s54, 3072
    s_add_u32 s58, s58, 138640
    v_add_u32 v5, s58, v4
    s_mov_b32 s77, 1048576
    s_branch KA_W16F
KA_W16:
    s_sleep 2
KA_W16F:
    ds_read_b128 v[160:163], v164 offset:0
    s_sub_u32 s77, s77, 1
    s_cbranch_scc1 KA_E17
    s_waitcnt lgkmcnt(0)
    v_or3_b32 v160, v160, v161, v162
    v_or_b32 v160, v160, v163
    v_cmp_ne_u32 vcc, 0, v160
    s_cbranch_vccnz KA_W16
KA_E17:
    ds_read_b128 v[32:35], v5 offset:0
    ds_read_b128 v[36:39], v5 offset:1024
    ds_read_b128 v[40:43], v5 offset:2048
    ds_read_b128 v[44:47], v5 offset:3072
    s_waitcnt lgkmcnt(3)
    v_lshlrev_b32 v56, 16, v32
    v_and_b32 v57, 0xffff0000, v32
    v_lshlrev_b32 v58, 16, v33
    v_and_b32 v59, 0xffff0000, v33
    v_add_f32 v57, v56, v57
    v_add_f32 v58, v57, v58
    v_add_f32 v59, v58, v59
    v_cvt_pk_bf16_f32 v32, v56, v57
    v_cvt_pk_bf16_f32 v33, v58, v59
    v_lshlrev_b32 v60, 16, v34
    v_and_b32 v61, 0xffff0000, v34
    v_lshlrev_b32 v62, 16, v35
    v_and_b32 v63, 0xffff0000, v35
    v_add_f32 v61, v60, v61
    v_add_f32 v62, v61, v62
    v_add_f32 v63, v62, v63
    v_cvt_pk_bf16_f32 v34, v60, v61
    v_cvt_pk_bf16_f32 v35, v62, v63
    ds_write_b128 v5, v[32:35] offset:13680
    s_waitcnt lgkmcnt(3)
    v_lshlrev_b32 v56, 16, v36
    v_and_b32 v57, 0xffff0000, v36
    v_lshlrev_b32 v58, 16, v37
    v_and_b32 v59, 0xffff0000, v37
    v_add_f32 v57, v56, v57
    v_add_f32 v58, v57, v58
    v_add_f32 v59, v58, v59
    v_cvt_pk_bf16_f32 v36, v56, v57
    v_cvt_pk_bf16_f32 v37, v58, v59
    v_lshlrev_b32 v60, 16, v38
    v_and_b32 v61, 0xffff0000, v38
    v_lshlrev_b32 v62, 16, v39
    v_and_b32 v63, 0xffff0000, v39
    v_add_f32 v61, v60, v61
    v_add_f32 v62, v61, v62
    v_add_f32 v63, v62, v63
    v_cvt_pk_bf16_f32 v38, v60, v61
    v_cvt_pk_bf16_f32 v39, v62, v63
    ds_write_b128 v5, v[36:39] offset:14704
    s_waitcnt lgkmcnt(3)
    v_lshlrev_b32 v56, 16, v40
    v_and_b32 v57, 0xffff0000, v40
    v_lshlrev_b32 v58, 16, v41
    v_and_b32 v59, 0xffff0000, v41
    v_add_f32 v57, v56, v57
    v_add_f32 v58, v57, v58
    v_add_f32 v59, v58, v59
    v_cvt_pk_bf16_f32 v40, v56, v57
    v_cvt_pk_bf16_f32 v41, v58, v59
    v_lshlrev_b32 v60, 16, v42
    v_and_b32 v61, 0xffff0000, v42
    v_lshlrev_b32 v62, 16, v43
    v_and_b32 v63, 0xffff0000, v43
    v_add_f32 v61, v60, v61
    v_add_f32 v62, v61, v62
    v_add_f32 v63, v62, v63
    v_cvt_pk_bf16_f32 v42, v60, v61
    v_cvt_pk_bf16_f32 v43, v62, v63
    ds_write_b128 v5, v[40:43] offset:15728
    s_waitcnt lgkmcnt(3)
    v_lshlrev_b32 v56, 16, v44
    v_and_b32 v57, 0xffff0000, v44
    v_lshlrev_b32 v58, 16, v45
    v_and_b32 v59, 0xffff0000, v45
    v_add_f32 v57, v56, v57
    v_add_f32 v58, v57, v58
    v_add_f32 v59, v58, v59
    v_cvt_pk_bf16_f32 v44, v56, v57
    v_cvt_pk_bf16_f32 v45, v58, v59
    v_lshlrev_b32 v60, 16, v46
    v_and_b32 v61, 0xffff0000, v46
    v_lshlrev_b32 v62, 16, v47
    v_and_b32 v63, 0xffff0000, v47
    v_add_f32 v61, v60, v61
    v_add_f32 v62, v61, v62
    v_add_f32 v63, v62, v63
    v_cvt_pk_bf16_f32 v46, v60, v61
    v_cvt_pk_bf16_f32 v47, v62, v63
    ds_write_b128 v5, v[44:47] offset:16752
    s_mov_b64 exec, 1
    ds_add_u32 v164, v165 offset:188
    s_mov_b64 exec, -1
    s_branch KA_ATT
KA_LG:
    ds_read_b128 v[64:67], v12 offset:0
    ds_read_b128 v[96:99], v40
    ds_read_b128 v[68:71], v12 offset:8192
    ds_read_b128 v[100:103], v41
    ds_read_b128 v[72:75], v12 offset:16384
    ds_read_b128 v[104:107], v42
    s_waitcnt vmcnt(7)
    s_barrier
    ds_read_b128 v[76:79], v12 offset:24576
    ds_read_b128 v[108:111], v43
    ds_read_b128 v[80:83], v12 offset:32768
    ds_read_b128 v[112:115], v44
    ds_read_b128 v[84:87], v12 offset:40960
    ds_read_b128 v[116:119], v45
    ds_read_b128 v[88:91], v12 offset:49152
    ds_read_b128 v[120:123], v46
    s_waitcnt vmcnt(3)
    s_barrier
    s_waitcnt lgkmcnt(6)
    ds_read_b128 v[92:95], v12 offset:57344
    ds_read_b128 v[124:127], v47
    s_waitcnt vmcnt(0) lgkmcnt(0)
    s_barrier
    v_mov_b32 v9, 0
    s_lshl_b32 s58, s50, 9
    s_add_u32 s58, s58, 6815744
    v_lshlrev_b32 v5, 3, v10
    v_dot2_f32_bf16 v9, v64, v96, v9
    v_dot2_f32_bf16 v9, v65, v97, v9
    v_dot2_f32_bf16 v9, v66, v98, v9
    v_dot2_f32_bf16 v9, v67, v99, v9
    v_dot2_f32_bf16 v9, v68, v100, v9
    v_dot2_f32_bf16 v9, v69, v101, v9
    v_dot2_f32_bf16 v9, v70, v102, v9
    v_dot2_f32_bf16 v9, v71, v103, v9
    v_dot2_f32_bf16 v9, v72, v104, v9
    v_dot2_f32_bf16 v9, v73, v105, v9
    v_dot2_f32_bf16 v9, v74, v106, v9
    v_dot2_f32_bf16 v9, v75, v107, v9
    v_dot2_f32_bf16 v9, v76, v108, v9
    v_dot2_f32_bf16 v9, v77, v109, v9
    v_dot2_f32_bf16 v9, v78, v110, v9
    v_dot2_f32_bf16 v9, v79, v111, v9
    v_dot2_f32_bf16 v9, v80, v112, v9
    v_dot2_f32_bf16 v9, v81, v113, v9
    v_dot2_f32_bf16 v9, v82, v114, v9
    v_dot2_f32_bf16 v9, v83, v115, v9
    v_dot2_f32_bf16 v9, v84, v116, v9
    v_dot2_f32_bf16 v9, v85, v117, v9
    v_dot2_f32_bf16 v9, v86, v118, v9
    v_dot2_f32_bf16 v9, v87, v119, v9
    v_dot2_f32_bf16 v9, v88, v120, v9
    v_dot2_f32_bf16 v9, v89, v121, v9
    v_dot2_f32_bf16 v9, v90, v122, v9
    v_dot2_f32_bf16 v9, v91, v123, v9
    v_dot2_f32_bf16 v9, v92, v124, v9
    v_dot2_f32_bf16 v9, v93, v125, v9
    v_dot2_f32_bf16 v9, v94, v126, v9
    v_dot2_f32_bf16 v9, v95, v127, v9
    s_nop 3
    v_add_f32_dpp v9, v9, v9 quad_perm:[1,0,3,2] row_mask:0xf bank_mask:0xf
    s_nop 1
    v_add_f32_dpp v9, v9, v9 quad_perm:[2,3,0,1] row_mask:0xf bank_mask:0xf
    s_nop 1
    v_add_f32_dpp v9, v9, v9 row_half_mirror row_mask:0xf bank_mask:0xf
    v_cvt_pk_bf16_f32 v9, v9, v9
    v_and_b32 v9, 0xffff0000, v9
    v_mul_f32 v9, 0xbfb8aa3b, v9
    v_exp_f32 v9, v9
    s_nop 0
    v_add_f32 v9, 1.0, v9
    v_rcp_f32 v9, v9
    s_nop 0
    v_cvt_pk_bf16_f32 v10, v9, v9
    v_and_b32 v10, 0xffff0000, v10
    v_sub_f32 v11, 1.0, v10
    v_cvt_pk_bf16_f32 v11, v11, v11
    v_and_b32 v11, 0xffff0000, v11
    s_mov_b32 exec_lo, 0x01010101
    s_mov_b32 exec_hi, 0x01010101
    buffer_store_dwordx2 v[10:11], v5, s[44:47], s58 offen sc1
    s_mov_b64 exec, -1
    s_branch KA_ATT
KA_CONS0:
KA_CONS:
    s_mul_i32 s51, s49, 851968
    v_lshlrev_b32 v4, 4, v1
    v_lshrrev_b32 v3, 5, v1
    v_mov_b32 v164, 163584
    v_mov_b32 v165, 1
    v_lshl_add_u32 v5, v1, 2, v164
    v_cmp_gt_u32 vcc, 24, v1
    v_mov_b32 v6, 0
    v_addc_co_u32 v6, vcc, 0, v6, vcc
    ds_write_b32 v5, v6
    s_setprio 3
    s_and_b32 s54, s48, 1
    s_lshr_b32 s55, s48, 1
    v_and_b32 v5, 31, v1
    s_lshl_b32 s56, s54, 12
    v_lshl_add_u32 v6, v5, 7, s56
    v_bfe_u32 v7, v5, 1, 3
    v_xor_b32 v7, v7, v3
    v_lshl_add_u32 v16, v7, 4, v6
    v_xor_b32 v17, 32, v16
    v_xor_b32 v18, 64, v16
    v_xor_b32 v19, 96, v16
    v_bfe_u32 v7, v1, 2, 2
    v_lshl_add_u32 v6, v3, 3, v7
    v_lshlrev_b32 v6, 7, v6
    v_lshrrev_b32 v7, 1, v7
    v_xor_b32 v7, s55, v7
    v_lshl_add_u32 v6, v7, 6, v6
    v_bfe_u32 v7, v1, 4, 1
    v_lshl_add_u32 v6, v7, 5, v6
    v_and_b32 v7, 3, v1
    v_lshl_add_u32 v6, v7, 3, v6
    v_add_u32 v20, 65536, v6
    v_mov_b32 v112, 0
    v_mov_b32 v113, 0
    v_mov_b32 v114, 0
    v_mov_b32 v115, 0
    v_mov_b32 v116, 0
    v_mov_b32 v117, 0
    v_mov_b32 v118, 0
    v_mov_b32 v119, 0
    v_mov_b32 v120, 0
    v_mov_b32 v121, 0
    v_mov_b32 v122, 0
    v_mov_b32 v123, 0
    v_mov_b32 v124, 0
    v_mov_b32 v125, 0
    v_mov_b32 v126, 0
    v_mov_b32 v127, 0
    v_mov_b32 v128, 0
    v_mov_b32 v129, 0
    v_mov_b32 v130, 0
    v_mov_b32 v131, 0
    v_mov_b32 v132, 0
    v_mov_b32 v133, 0
    v_mov_b32 v134, 0
    v_mov_b32 v135, 0
    v_mov_b32 v136, 0
    v_mov_b32 v137, 0
    v_mov_b32 v138, 0
    v_mov_b32 v139, 0
    v_mov_b32 v140, 0
    v_mov_b32 v141, 0
    v_mov_b32 v142, 0
    v_mov_b32 v143, 0
    v_mov_b32 v144, 0
    v_mov_b32 v145, 0
    v_mov_b32 v146, 0
    v_mov_b32 v147, 0
    v_mov_b32 v148, 0
    v_mov_b32 v149, 0
    v_mov_b32 v150, 0
    v_mov_b32 v151, 0
    v_mov_b32 v152, 0
    v_mov_b32 v153, 0
    v_mov_b32 v154, 0
    v_mov_b32 v155, 0
    v_mov_b32 v156, 0
    v_mov_b32 v157, 0
    v_mov_b32 v158, 0
    v_mov_b32 v159, 0
    s_lshl_b32 s58, s48, 10
    v_add_u32 v5, s58, v4
    v_add_u32 v6, 150928, v5
    ds_write_b128 v6, v[112:115]
    v_cmp_gt_u32 vcc, 2448, v5
    v_add_u32 v6, 139264, v5
    s_and_saveexec_b64 s[60:61], vcc
    ds_write_b128 v6, v[112:115]
    s_mov_b64 exec, 0x7fffff
    v_add_u32 v6, 155024, v4
    ds_write_b128 v6, v[112:115]
    s_mov_b64 exec, -1
    s_waitcnt lgkmcnt(0)
    s_mov_b32 s44, s34
    s_and_b32 s45, s35, 0xffff
    s_mov_b32 s46, 11091968
    s_mov_b32 s47, 0x20000
    v_lshrrev_b32 v25, 1, v1
    v_xor_b32 v25, v25, v1
    v_and_b32 v25, 4, v25
    v_mul_u32_u24 v25, 3, v25
    v_xor_b32 v25, v25, v1
    v_lshlrev_b32 v25, 4, v25
    v_mov_b32 v22, v20
    s_mov_b32 s58, 0
    s_mov_b32 s57, 3
    s_barrier
    ds_read_b128 v[32:35], v16 offset:0
    ds_read_b64_tr_b16 v[36:37], v20 offset:0
    ds_read_b64_tr_b16 v[38:39], v20 offset:512
    ds_read_b64_tr_b16 v[40:41], v20 offset:4096
    ds_read_b64_tr_b16 v[42:43], v20 offset:4608
    ds_read_b64_tr_b16 v[44:45], v20 offset:8192
    ds_read_b64_tr_b16 v[46:47], v20 offset:8704
    ds_read_b128 v[48:51], v17 offset:0
    ds_read_b64_tr_b16 v[52:53], v20 offset:2048
    ds_read_b64_tr_b16 v[54:55], v20 offset:2560
    ds_read_b64_tr_b16 v[56:57], v20 offset:6144
    ds_read_b64_tr_b16 v[58:59], v20 offset:6656
    ds_read_b64_tr_b16 v[60:61], v20 offset:10240
    ds_read_b64_tr_b16 v[62:63], v20 offset:10752
.p2align 6
KA_GEMM:
    s_add_u32 s58, s58, 12288
    s_cmp_eq_u32 s58, 73728
    s_cselect_b32 s58, 0, s58
    v_add_u32 v20, s58, v22
    s_waitcnt lgkmcnt(7)
    v_mfma_f32_32x32x16_bf16 v[112:127], v[36:39], v[32:35], v[112:127]
    s_barrier
    ds_read_b128 v[64:67], v18 offset:0
    ds_read_b64_tr_b16 v[68:69], v20 offset:0
    ds_read_b64_tr_b16 v[70:71], v20 offset:512
    v_mfma_f32_32x32x16_bf16 v[128:143], v[40:43], v[32:35], v[128:143]
    ds_read_b64_tr_b16 v[72:73], v20 offset:4096
    ds_read_b64_tr_b16 v[74:75], v20 offset:4608
    ds_read_b64_tr_b16 v[76:77], v20 offset:8192
    v_mfma_f32_32x32x16_bf16 v[144:159], v[32:35], v[44:47], v[144:159]
    ds_read_b64_tr_b16 v[78:79], v20 offset:8704
    s_waitcnt lgkmcnt(7)
    v_mfma_f32_32x32x16_bf16 v[112:127], v[52:55], v[48:51], v[112:127]
    ds_read_b128 v[80:83], v19 offset:0
    ds_read_b64_tr_b16 v[84:85], v20 offset:2048
    ds_read_b64_tr_b16 v[86:87], v20 offset:2560
    v_mfma_f32_32x32x16_bf16 v[128:143], v[56:59], v[48:51], v[128:143]
    ds_read_b64_tr_b16 v[88:89], v20 offset:6144
    ds_read_b64_tr_b16 v[90:91], v20 offset:6656
    ds_read_b64_tr_b16 v[92:93], v20 offset:10240
    v_mfma_f32_32x32x16_bf16 v[144:159], v[48:51], v[60:63], v[144:159]
    ds_read_b64_tr_b16 v[94:95], v20 offset:10752
    s_add_u32 s58, s58, 12288
    s_cmp_eq_u32 s58, 73728
    s_cselect_b32 s58, 0, s58
    v_add_u32 v20, s58, v22
    s_waitcnt lgkmcnt(7)
    v_mfma_f32_32x32x16_bf16 v[112:127], v[68:71], v[64:67], v[112:127]
    s_barrier
    ds_read_b128 v[32:35], v16 offset:8192
    ds_read_b64_tr_b16 v[36:37], v20 offset:0
    ds_read_b64_tr_b16 v[38:39], v20 offset:512
    v_mfma_f32_32x32x16_bf16 v[128:143], v[72:75], v[64:67], v[128:143]
    ds_read_b64_tr_b16 v[40:41], v20 offset:4096
    ds_read_b64_tr_b16 v[42:43], v20 offset:4608
    ds_read_b64_tr_b16 v[44:45], v20 offset:8192
    v_mfma_f32_32x32x16_bf16 v[144:159], v[64:67], v[76:79], v[144:159]
    ds_read_b64_tr_b16 v[46:47], v20 offset:8704
    s_waitcnt lgkmcnt(7)
    v_mfma_f32_32x32x16_bf16 v[112:127], v[84:87], v[80:83], v[112:127]
    ds_read_b128 v[48:51], v17 offset:8192
    ds_read_b64_tr_b16 v[52:53], v20 offset:2048
    ds_read_b64_tr_b16 v[54:55], v20 offset:2560
    v_mfma_f32_32x32x16_bf16 v[128:143], v[88:91], v[80:83], v[128:143]
    ds_read_b64_tr_b16 v[56:57], v20 offset:6144
    ds_read_b64_tr_b16 v[58:59], v20 offset:6656
    ds_read_b64_tr_b16 v[60:61], v20 offset:10240
    v_mfma_f32_32x32x16_bf16 v[144:159], v[80:83], v[92:95], v[144:159]
    ds_read_b64_tr_b16 v[62:63], v20 offset:10752
    s_add_u32 s58, s58, 12288
    s_cmp_eq_u32 s58, 73728
    s_cselect_b32 s58, 0, s58
    v_add_u32 v20, s58, v22
    s_waitcnt lgkmcnt(7)
    v_mfma_f32_32x32x16_bf16 v[112:127], v[36:39], v[32:35], v[112:127]
    s_barrier
    ds_read_b128 v[64:67], v18 offset:8192
    ds_read_b64_tr_b16 v[68:69], v20 offset:0
    ds_read_b64_tr_b16 v[70:71], v20 offset:512
    v_mfma_f32_32x32x16_bf16 v[128:143], v[40:43], v[32:35], v[128:143]
    ds_read_b64_tr_b16 v[72:73], v20 offset:4096
    ds_read_b64_tr_b16 v[74:75], v20 offset:4608
    ds_read_b64_tr_b16 v[76:77], v20 offset:8192
    v_mfma_f32_32x32x16_bf16 v[144:159], v[32:35], v[44:47], v[144:159]
    ds_read_b64_tr_b16 v[78:79], v20 offset:8704
    s_waitcnt lgkmcnt(7)
    v_mfma_f32_32x32x16_bf16 v[112:127], v[52:55], v[48:51], v[112:127]
    ds_read_b128 v[80:83], v19 offset:8192
    ds_read_b64_tr_b16 v[84:85], v20 offset:2048
    ds_read_b64_tr_b16 v[86:87], v20 offset:2560
    v_mfma_f32_32x32x16_bf16 v[128:143], v[56:59], v[48:51], v[128:143]
    ds_read_b64_tr_b16 v[88:89], v20 offset:6144
    ds_read_b64_tr_b16 v[90:91], v20 offset:6656
    ds_read_b64_tr_b16 v[92:93], v20 offset:10240
    v_mfma_f32_32x32x16_bf16 v[144:159], v[48:51], v[60:63], v[144:159]
    ds_read_b64_tr_b16 v[94:95], v20 offset:10752
    s_add_u32 s58, s58, 12288
    s_cmp_eq_u32 s58, 73728
    s_cselect_b32 s58, 0, s58
    v_add_u32 v20, s58, v22
    s_cmp_eq_u32 s57, 0
    s_waitcnt lgkmcnt(7)
    v_mfma_f32_32x32x16_bf16 v[112:127], v[68:71], v[64:67], v[112:127]
    s_cbranch_scc1 KA_GEND
    s_barrier
    ds_read_b128 v[32:35], v16 offset:16384
    ds_read_b64_tr_b16 v[36:37], v20 offset:0
    ds_read_b64_tr_b16 v[38:39], v20 offset:512
    v_mfma_f32_32x32x16_bf16 v[128:143], v[72:75], v[64:67], v[128:143]
    ds_read_b64_tr_b16 v[40:41], v20 offset:4096
    ds_read_b64_tr_b16 v[42:43], v20 offset:4608
    ds_read_b64_tr_b16 v[44:45], v20 offset:8192
    v_mfma_f32_32x32x16_bf16 v[144:159], v[64:67], v[76:79], v[144:159]
    ds_read_b64_tr_b16 v[46:47], v20 offset:8704
    s_waitcnt lgkmcnt(7)
    v_mfma_f32_32x32x16_bf16 v[112:127], v[84:87], v[80:83], v[112:127]
    ds_read_b128 v[48:51], v17 offset:16384
    ds_read_b64_tr_b16 v[52:53], v20 offset:2048
    ds_read_b64_tr_b16 v[54:55], v20 offset:2560
    v_mfma_f32_32x32x16_bf16 v[128:143], v[88:91], v[80:83], v[128:143]
    ds_read_b64_tr_b16 v[56:57], v20 offset:6144
    ds_read_b64_tr_b16 v[58:59], v20 offset:6656
    ds_read_b64_tr_b16 v[60:61], v20 offset:10240
    v_mfma_f32_32x32x16_bf16 v[144:159], v[80:83], v[92:95], v[144:159]
    ds_read_b64_tr_b16 v[62:63], v20 offset:10752
    v_add_u32 v16, 16384, v16
    v_add_u32 v17, 16384, v17
    v_add_u32 v18, 16384, v18
    v_add_u32 v19, 16384, v19
    s_sub_u32 s57, s57, 1
    s_branch KA_GEMM
KA_GEND:
    v_mfma_f32_32x32x16_bf16 v[128:143], v[72:75], v[64:67], v[128:143]
    v_mfma_f32_32x32x16_bf16 v[144:159], v[64:67], v[76:79], v[144:159]
    s_waitcnt lgkmcnt(0)
    v_mfma_f32_32x32x16_bf16 v[112:127], v[84:87], v[80:83], v[112:127]
    v_mfma_f32_32x32x16_bf16 v[128:143], v[88:91], v[80:83], v[128:143]
    v_mfma_f32_32x32x16_bf16 v[144:159], v[80:83], v[92:95], v[144:159]
    s_lshl_b32 s58, s50, 1
    s_add_u32 s58, s58, s54
    s_lshl_b32 s58, s58, 10
    s_mul_i32 s59, s55, 262144
    s_add_u32 s58, s58, s59
    s_add_u32 s58, s58, s51
    s_add_u32 s59, s58, 131072
    s_add_u32 s62, s58, 65536
    s_mov_b32 s63, 0x3eb8aa3b
    v_bfe_u32 v5, v1, 4, 1
    v_mul_u32_u24 v5, 131072, v5
    v_and_b32 v6, 15, v1
    v_lshl_add_u32 v6, v3, 4, v6
    v_lshl_add_u32 v6, v6, 4, v5
    v_cvt_pk_bf16_f32 v16, v128, v129
    v_cvt_pk_bf16_f32 v17, v130, v131
    v_cvt_pk_bf16_f32 v18, v132, v133
    v_cvt_pk_bf16_f32 v19, v134, v135
    v_cvt_pk_bf16_f32 v20, v136, v137
    v_cvt_pk_bf16_f32 v21, v138, v139
    v_cvt_pk_bf16_f32 v22, v140, v141
    v_cvt_pk_bf16_f32 v23, v142, v143
    buffer_store_dwordx4 v[16:19], v25, s[44:47], s58 offen sc1
    buffer_store_dwordx4 v[20:23], v25, s[44:47], s59 offen sc1
    v_cvt_pk_bf16_f32 v96, v144, v145
    v_cvt_pk_bf16_f32 v97, v146, v147
    v_cvt_pk_bf16_f32 v98, v148, v149
    v_cvt_pk_bf16_f32 v99, v150, v151
    v_cvt_pk_bf16_f32 v100, v152, v153
    v_cvt_pk_bf16_f32 v101, v154, v155
    v_cvt_pk_bf16_f32 v102, v156, v157
    v_cvt_pk_bf16_f32 v103, v158, v159
    buffer_store_dwordx4 v[96:99], v6, s[44:47], s62 offen sc1
    buffer_store_dwordx4 v[100:103], v6, s[44:47], s62 offen offset:512 sc1
    s_mov_b32 s77, 1048576
KA_W18:
    ds_read_b32 v166, v164 offset:108
    s_sub_u32 s77, s77, 1
    s_cbranch_scc1 KA_E19
    s_waitcnt lgkmcnt(0)
    v_readfirstlane_b32 s52, v166
    s_cmp_lt_u32 s52, 1
    s_cbranch_scc1 KA_W18
KA_E19:
    v_mul_f32 v112, s63, v112
    v_mul_f32 v113, s63, v113
    v_mul_f32 v114, s63, v114
    v_mul_f32 v115, s63, v115
    v_mul_f32 v116, s63, v116
    v_mul_f32 v117, s63, v117
    v_mul_f32 v118, s63, v118
    v_mul_f32 v119, s63, v119
    v_mul_f32 v120, s63, v120
    v_mul_f32 v121, s63, v121
    v_mul_f32 v122, s63, v122
    v_mul_f32 v123, s63, v123
    v_mul_f32 v124, s63, v124
    v_mul_f32 v125, s63, v125
    v_mul_f32 v126, s63, v126
    v_mul_f32 v127, s63, v127
    s_lshl_b32 s60, s55, 12
    s_lshl_b32 s61, s54, 10
    s_add_u32 s60, s60, s61
    s_add_u32 s60, s60, 114688
    v_add_u32 v5, s60, v4
    v_cvt_pk_bf16_f32 v32, v112, v113
    v_cvt_pk_bf16_f32 v33, v114, v115
    v_cvt_pk_bf16_f32 v34, v116, v117
    v_cvt_pk_bf16_f32 v35, v118, v119
    v_cvt_pk_bf16_f32 v36, v120, v121
    v_cvt_pk_bf16_f32 v37, v122, v123
    v_cvt_pk_bf16_f32 v38, v124, v125
    v_cvt_pk_bf16_f32 v39, v126, v127
    ds_write_b128 v5, v[32:35]
    ds_write_b128 v5, v[36:39] offset:2048
    s_mov_b64 exec, 1
    ds_add_u32 v164, v165 offset:104
    s_mov_b64 exec, -1
    s_getreg_b32 s66, hwreg(HW_REG_XCC_ID)
    s_and_b32 s66, s66, 15
    s_add_u32 s66, s66, 1
    s_lshl_b32 s66, s66, 1
    s_xor_b32 s66, s66, s52
    s_add_u32 s67, s51, 786944
    s_lshl_b32 s60, s48, 7
    s_lshl_b32 s61, s50, 2
    s_add_u32 s60, s60, s61
    v_mov_b32 v156, s60
    s_waitcnt vmcnt(0)
    v_mov_b32 v155, s66
    s_mov_b64 exec, 1
    buffer_store_dword v155, v156, s[44:47], s67 offen
    s_mov_b64 exec, -1
    s_mov_b64 exec, 1
    ds_add_u32 v164, v165 offset:176
    s_mov_b64 exec, -1
    s_branch KA_ATT
KA_AUX0:
    s_mul_i32 s51, s49, 851968
    v_lshlrev_b32 v4, 4, v1
    v_lshrrev_b32 v3, 5, v1
    v_mov_b32 v164, 163584
    v_mov_b32 v165, 1
KA_AUX:
    s_and_b32 s61, s54, 1
    s_lshr_b32 s62, s54, 1
    s_mov_b32 s52, 0
    s_mov_b32 s44, s34
    s_and_b32 s45, s35, 0xffff
    s_mov_b32 s46, 11091968
    s_mov_b32 s47, 0x20000
    s_lshl_b32 s63, s2, 2
    s_add_u32 s63, s63, s54
    s_cmp_lg_u32 s63, 3
    s_cbranch_scc1 KA_NOPUB
    s_memrealtime s[64:65]
    s_waitcnt lgkmcnt(0)
    s_or_b32 s64, s64, 1
    v_mov_b32 v158, 0
    v_mov_b32 v159, s64
    s_mov_b64 exec, 1
    global_store_dword v158, v159, s[32:33] sc1
    s_mov_b64 exec, -1
KA_NOPUB:
    v_and_b32 v7, 31, v1
    v_and_b32 v36, 1, v1
    v_lshlrev_b32 v36, 4, v36
    v_mov_b32 v37, 0x3f80
    v_lshlrev_b32 v36, v36, v37
    v_bfe_u32 v37, v1, 1, 2
    v_cmp_eq_u32 s[64:65], 0, v37
    v_cmp_eq_u32 s[66:67], 1, v37
    v_cmp_eq_u32 s[68:69], 2, v37
    v_cmp_eq_u32 s[70:71], 3, v37
    s_nop 0
    v_cndmask_b32 v160, 0, v36, s[64:65]
    v_cndmask_b32 v161, 0, v36, s[66:67]
    v_cndmask_b32 v162, 0, v36, s[68:69]
    v_cndmask_b32 v163, 0, v36, s[70:71]
    s_lshl_b32 s63, s54, 11
    s_add_u32 s63, s63, 141712
    v_add_u32 v16, s63, v4
    s_mul_i32 s63, s62, 4160
    s_add_u32 s63, s63, 18688
    v_lshl_add_u32 v19, v7, 4, s63
    s_lshl_b32 s64, s62, 2
    v_add_u32 v167, s64, v164
    v_lshrrev_b32 v32, 2, v7
    v_lshlrev_b32 v32, 3, v32
    v_sub_u32 v33, 4128, v32
    v_lshl_add_u32 v33, v3, 4, v33
    v_and_b32 v32, 3, v7
    v_mul_u32_u24 v32, 8384, v32
    s_lshl_b32 s64, s61, 6
    s_sub_u32 s64, s63, s64
    s_sub_u32 s64, s64, 416
    v_add3_u32 v38, v32, v33, s64
    v_mul_u32_u24 v39, 144, v7
    v_lshl_add_u32 v39, v3, 5, v39
    s_lshl_b32 s64, s62, 4
    s_mul_i32 s65, s61, 144
    s_sub_u32 s64, s64, s65
    s_add_u32 s64, s64, 140848
    v_add_u32 v39, s64, v39
    s_lshl_b32 s64, s54, 6
    v_add_u32 v32, s64, v1
    v_mul_u32_u24 v33, 7282, v32
    v_lshrrev_b32 v33, 16, v33
    v_mul_u32_u24 v34, 9, v33
    v_sub_u32 v34, v32, v34
    v_min_u32 v34, 7, v34
    v_lshrrev_b32 v35, 1, v34
    v_lshl_add_u32 v33, v33, 2, v35
    v_and_b32 v34, 1, v34
    v_lshlrev_b32 v34, 4, v34
    v_lshl_add_u32 v2, v33, 10, v34
    v_add_u32 v32, s64, v1
    v_add_u32 v32, 256, v32
    v_mul_u32_u24 v33, 7282, v32
    v_lshrrev_b32 v33, 16, v33
    v_mul_u32_u24 v34, 9, v33
    v_sub_u32 v34, v32, v34
    v_min_u32 v34, 7, v34
    v_lshrrev_b32 v35, 1, v34
    v_lshl_add_u32 v33, v33, 2, v35
    v_and_b32 v34, 1, v34
    v_lshlrev_b32 v34, 4, v34
    v_lshl_add_u32 v5, v33, 10, v34
    v_add_u32 v32, s64, v1
    v_add_u32 v32, 512, v32
    v_mul_u32_u24 v33, 7282, v32
    v_lshrrev_b32 v33, 16, v33
    v_mul_u32_u24 v34, 9, v33
    v_sub_u32 v34, v32, v34
    v_min_u32 v34, 7, v34
    v_lshrrev_b32 v35, 1, v34
    v_lshl_add_u32 v33, v33, 2, v35
    v_and_b32 v34, 1, v34
    v_lshlrev_b32 v34, 4, v34
    v_lshl_add_u32 v6, v33, 10, v34
    s_lshl_b32 s74, s50, 5
    s_add_u32 s74, s74, s51
    s_add_u32 s74, s74, 524288
    s_lshl_b32 s75, s54, 10
    s_add_u32 s75, s75, 141712
    s_lshl_b32 s60, s54, 2
    s_add_u32 s60, s60, 163584
    s_lshl_b32 s58, s61, 12
    s_sub_u32 s58, 2048, s58
    s_mov_b32 s63, 0x3fb8aa3b
    s_waitcnt vmcnt(7)
    v_mul_f32 v17, s63, v14
    v_fma_f32 v18, v14, s63, -v17
    v_fmac_f32 v18, 0x32a57060, v14
    v_exp_f32 v17, v17
    v_mul_f32 v18, 0x3f317218, v18
    v_fma_f32 v17, v17, v18, v17
    v_cvt_pk_bf16_f32 v17, v17, v17
    v_and_b32 v17, 0xffff0000, v17
    s_waitcnt vmcnt(0)
    v_mul_f32 v8, v17, v8
    v_mul_f32 v9, v17, v9
    v_mul_f32 v10, v17, v10
    v_mul_f32 v11, v17, v11
    v_mul_f32 v8, s63, v8
    v_mul_f32 v9, 0.15915494, v9
    v_mul_f32 v32, 0x3f800000, v8
    v_mul_f32 v33, 0x3f800000, v9
    v_mul_f32 v34, 0x41000000, v8
    v_mul_f32 v35, 0x41000000, v9
    v_mul_f32 v36, 0x43800000, v8
    v_mul_f32 v37, 0x43800000, v9
    v_exp_f32 v32, v32
    v_fract_f32 v33, v33
    v_exp_f32 v34, v34
    v_fract_f32 v35, v35
    v_exp_f32 v36, v36
    v_fract_f32 v37, v37
    v_cos_f32 v20, v33
    v_sin_f32 v21, v33
    v_cos_f32 v22, v35
    v_sin_f32 v23, v35
    v_cos_f32 v24, v37
    v_sin_f32 v25, v37
    v_pk_mul_f32 v[40:41], v[12:13], v[10:11] op_sel:[0,0] op_sel_hi:[0,1]
    v_pk_fma_f32 v[40:41], v[12:13], v[10:11], v[40:41] op_sel:[1,1,0] op_sel_hi:[1,0,1] neg_lo:[0,1,0]
    v_mul_f32 v20, v32, v20
    v_mul_f32 v21, v32, v21
    v_mul_f32 v22, v34, v22
    v_mul_f32 v23, v34, v23
    v_mul_f32 v24, v36, v24
    v_mul_f32 v25, v36, v25
    v_pk_mul_f32 v[26:27], v[20:21], v[20:21] op_sel:[0,0] op_sel_hi:[0,1]
    v_pk_mul_f32 v[30:31], v[22:23], v[22:23] op_sel:[0,0] op_sel_hi:[0,1]
    v_pk_fma_f32 v[26:27], v[20:21], v[20:21], v[26:27] op_sel:[1,1,0] op_sel_hi:[1,0,1] neg_lo:[0,1,0]
    v_pk_fma_f32 v[30:31], v[22:23], v[22:23], v[30:31] op_sel:[1,1,0] op_sel_hi:[1,0,1] neg_lo:[0,1,0]
    v_pk_mul_f32 v[28:29], v[26:27], v[26:27] op_sel:[0,0] op_sel_hi:[0,1]
    v_pk_fma_f32 v[28:29], v[26:27], v[26:27], v[28:29] op_sel:[1,1,0] op_sel_hi:[1,0,1] neg_lo:[0,1,0]
    v_cvt_pk_bf16_f32 v127, v22, 1.0
    v_pk_mul_f32 v[42:43], v[40:41], v[24:25] op_sel:[0,0] op_sel_hi:[0,1]
    v_cvt_pk_bf16_f32 v143, v23, 0
    v_pk_mul_f32 v[68:69], v[40:41], v[20:21] op_sel:[0,0] op_sel_hi:[0,1]
    v_pk_mul_f32 v[100:101], v[22:23], v[30:31] op_sel:[0,0] op_sel_hi:[0,1]
    v_pk_fma_f32 v[42:43], v[40:41], v[24:25], v[42:43] op_sel:[1,1,0] op_sel_hi:[1,0,1] neg_lo:[0,1,0]
    v_pk_fma_f32 v[100:101], v[22:23], v[30:31], v[100:101] op_sel:[1,1,0] op_sel_hi:[1,0,1] neg_lo:[0,1,0]
    v_pk_fma_f32 v[68:69], v[40:41], v[20:21], v[68:69] op_sel:[1,1,0] op_sel_hi:[1,0,1] neg_lo:[0,1,0]
    v_pk_mul_f32 v[98:99], v[30:31], v[30:31] op_sel:[0,0] op_sel_hi:[0,1]
    v_pk_mul_f32 v[44:45], v[42:43], v[24:25] op_sel:[0,0] op_sel_hi:[0,1]
    v_pk_mul_f32 v[102:103], v[100:101], v[30:31] op_sel:[0,0] op_sel_hi:[0,1]
    v_pk_mul_f32 v[70:71], v[68:69], v[20:21] op_sel:[0,0] op_sel_hi:[0,1]
    v_cvt_pk_bf16_f32 v126, v100, v30
    v_pk_fma_f32 v[44:45], v[42:43], v[24:25], v[44:45] op_sel:[1,1,0] op_sel_hi:[1,0,1] neg_lo:[0,1,0]
    v_pk_fma_f32 v[98:99], v[30:31], v[30:31], v[98:99] op_sel:[1,1,0] op_sel_hi:[1,0,1] neg_lo:[0,1,0]
    v_pk_fma_f32 v[70:71], v[68:69], v[20:21], v[70:71] op_sel:[1,1,0] op_sel_hi:[1,0,1] neg_lo:[0,1,0]
    v_pk_fma_f32 v[102:103], v[100:101], v[30:31], v[102:103] op_sel:[1,1,0] op_sel_hi:[1,0,1] neg_lo:[0,1,0]
    v_pk_mul_f32 v[46:47], v[44:45], v[24:25] op_sel:[0,0] op_sel_hi:[0,1]
    v_cvt_pk_bf16_f32 v142, v101, v31
    v_pk_mul_f32 v[72:73], v[70:71], v[20:21] op_sel:[0,0] op_sel_hi:[0,1]
    v_pk_mul_f32 v[96:97], v[98:99], v[30:31] op_sel:[0,0] op_sel_hi:[0,1]
    v_pk_fma_f32 v[46:47], v[44:45], v[24:25], v[46:47] op_sel:[1,1,0] op_sel_hi:[1,0,1] neg_lo:[0,1,0]
    v_pk_mul_f32 v[100:101], v[102:103], v[30:31] op_sel:[0,0] op_sel_hi:[0,1]
    v_pk_fma_f32 v[72:73], v[70:71], v[20:21], v[72:73] op_sel:[1,1,0] op_sel_hi:[1,0,1] neg_lo:[0,1,0]
    v_cvt_pk_bf16_f32 v125, v102, v98
    v_pk_mul_f32 v[48:49], v[46:47], v[24:25] op_sel:[0,0] op_sel_hi:[0,1]
    v_pk_fma_f32 v[96:97], v[98:99], v[30:31], v[96:97] op_sel:[1,1,0] op_sel_hi:[1,0,1] neg_lo:[0,1,0]
    v_pk_mul_f32 v[74:75], v[72:73], v[20:21] op_sel:[0,0] op_sel_hi:[0,1]
    v_pk_fma_f32 v[100:101], v[102:103], v[30:31], v[100:101] op_sel:[1,1,0] op_sel_hi:[1,0,1] neg_lo:[0,1,0]
    v_pk_fma_f32 v[48:49], v[46:47], v[24:25], v[48:49] op_sel:[1,1,0] op_sel_hi:[1,0,1] neg_lo:[0,1,0]
    v_cvt_pk_bf16_f32 v141, v103, v99
    v_pk_fma_f32 v[74:75], v[72:73], v[20:21], v[74:75] op_sel:[1,1,0] op_sel_hi:[1,0,1] neg_lo:[0,1,0]
    v_pk_mul_f32 v[98:99], v[96:97], v[30:31] op_sel:[0,0] op_sel_hi:[0,1]
    v_pk_mul_f32 v[50:51], v[48:49], v[24:25] op_sel:[0,0] op_sel_hi:[0,1]
    v_pk_mul_f32 v[102:103], v[100:101], v[30:31] op_sel:[0,0] op_sel_hi:[0,1]
    v_pk_mul_f32 v[76:77], v[74:75], v[20:21] op_sel:[0,0] op_sel_hi:[0,1]
    v_cvt_pk_bf16_f32 v124, v100, v96
    v_pk_fma_f32 v[50:51], v[48:49], v[24:25], v[50:51] op_sel:[1,1,0] op_sel_hi:[1,0,1] neg_lo:[0,1,0]
    v_pk_fma_f32 v[98:99], v[96:97], v[30:31], v[98:99] op_sel:[1,1,0] op_sel_hi:[1,0,1] neg_lo:[0,1,0]
    v_pk_fma_f32 v[76:77], v[74:75], v[20:21], v[76:77] op_sel:[1,1,0] op_sel_hi:[1,0,1] neg_lo:[0,1,0]
    v_pk_fma_f32 v[102:103], v[100:101], v[30:31], v[102:103] op_sel:[1,1,0] op_sel_hi:[1,0,1] neg_lo:[0,1,0]
    v_pk_mul_f32 v[52:53], v[50:51], v[24:25] op_sel:[0,0] op_sel_hi:[0,1]
    v_cvt_pk_bf16_f32 v140, v101, v97
    v_pk_mul_f32 v[78:79], v[76:77], v[20:21] op_sel:[0,0] op_sel_hi:[0,1]
    v_pk_mul_f32 v[96:97], v[98:99], v[30:31] op_sel:[0,0] op_sel_hi:[0,1]
    v_pk_fma_f32 v[52:53], v[50:51], v[24:25], v[52:53] op_sel:[1,1,0] op_sel_hi:[1,0,1] neg_lo:[0,1,0]
    v_pk_mul_f32 v[100:101], v[102:103], v[30:31] op_sel:[0,0] op_sel_hi:[0,1]
    v_pk_fma_f32 v[78:79], v[76:77], v[20:21], v[78:79] op_sel:[1,1,0] op_sel_hi:[1,0,1] neg_lo:[0,1,0]
    v_cvt_pk_bf16_f32 v123, v102, v98
    v_pk_mul_f32 v[54:55], v[52:53], v[24:25] op_sel:[0,0] op_sel_hi:[0,1]
    v_pk_fma_f32 v[96:97], v[98:99], v[30:31], v[96:97] op_sel:[1,1,0] op_sel_hi:[1,0,1] neg_lo:[0,1,0]
    v_pk_mul_f32 v[80:81], v[78:79], v[20:21] op_sel:[0,0] op_sel_hi:[0,1]
    v_pk_fma_f32 v[100:101], v[102:103], v[30:31], v[100:101] op_sel:[1,1,0] op_sel_hi:[1,0,1] neg_lo:[0,1,0]
    v_pk_fma_f32 v[54:55], v[52:53], v[24:25], v[54:55] op_sel:[1,1,0] op_sel_hi:[1,0,1] neg_lo:[0,1,0]
    v_cvt_pk_bf16_f32 v139, v103, v99
    v_pk_fma_f32 v[80:81], v[78:79], v[20:21], v[80:81] op_sel:[1,1,0] op_sel_hi:[1,0,1] neg_lo:[0,1,0]
    v_pk_mul_f32 v[98:99], v[96:97], v[30:31] op_sel:[0,0] op_sel_hi:[0,1]
    v_pk_mul_f32 v[56:57], v[48:49], v[22:23] op_sel:[0,0] op_sel_hi:[0,1]
    v_pk_mul_f32 v[102:103], v[100:101], v[30:31] op_sel:[0,0] op_sel_hi:[0,1]
    v_pk_mul_f32 v[82:83], v[80:81], v[20:21] op_sel:[0,0] op_sel_hi:[0,1]
    v_cvt_pk_bf16_f32 v122, v100, v96
    v_pk_fma_f32 v[56:57], v[48:49], v[22:23], v[56:57] op_sel:[1,1,0] op_sel_hi:[1,0,1] neg_lo:[0,1,0]
    v_pk_fma_f32 v[98:99], v[96:97], v[30:31], v[98:99] op_sel:[1,1,0] op_sel_hi:[1,0,1] neg_lo:[0,1,0]
    v_pk_fma_f32 v[82:83], v[80:81], v[20:21], v[82:83] op_sel:[1,1,0] op_sel_hi:[1,0,1] neg_lo:[0,1,0]
    v_pk_fma_f32 v[102:103], v[100:101], v[30:31], v[102:103] op_sel:[1,1,0] op_sel_hi:[1,0,1] neg_lo:[0,1,0]
    v_pk_mul_f32 v[58:59], v[50:51], v[22:23] op_sel:[0,0] op_sel_hi:[0,1]
    v_cvt_pk_bf16_f32 v138, v101, v97
    v_pk_mul_f32 v[84:85], v[42:43], v[26:27] op_sel:[0,0] op_sel_hi:[0,1]
    v_pk_mul_f32 v[96:97], v[98:99], v[30:31] op_sel:[0,0] op_sel_hi:[0,1]
    v_pk_fma_f32 v[58:59], v[50:51], v[22:23], v[58:59] op_sel:[1,1,0] op_sel_hi:[1,0,1] neg_lo:[0,1,0]
    v_pk_mul_f32 v[100:101], v[102:103], v[30:31] op_sel:[0,0] op_sel_hi:[0,1]
    v_pk_fma_f32 v[84:85], v[42:43], v[26:27], v[84:85] op_sel:[1,1,0] op_sel_hi:[1,0,1] neg_lo:[0,1,0]
    v_cvt_pk_bf16_f32 v121, v102, v98
    v_pk_mul_f32 v[60:61], v[52:53], v[22:23] op_sel:[0,0] op_sel_hi:[0,1]
    v_pk_fma_f32 v[96:97], v[98:99], v[30:31], v[96:97] op_sel:[1,1,0] op_sel_hi:[1,0,1] neg_lo:[0,1,0]
    v_pk_mul_f32 v[86:87], v[84:85], v[26:27] op_sel:[0,0] op_sel_hi:[0,1]
    v_pk_fma_f32 v[100:101], v[102:103], v[30:31], v[100:101] op_sel:[1,1,0] op_sel_hi:[1,0,1] neg_lo:[0,1,0]
    v_pk_fma_f32 v[60:61], v[52:53], v[22:23], v[60:61] op_sel:[1,1,0] op_sel_hi:[1,0,1] neg_lo:[0,1,0]
    v_cvt_pk_bf16_f32 v137, v103, v99
    v_pk_fma_f32 v[86:87], v[84:85], v[26:27], v[86:87] op_sel:[1,1,0] op_sel_hi:[1,0,1] neg_lo:[0,1,0]
    v_pk_mul_f32 v[98:99], v[96:97], v[30:31] op_sel:[0,0] op_sel_hi:[0,1]
    v_pk_mul_f32 v[62:63], v[54:55], v[22:23] op_sel:[0,0] op_sel_hi:[0,1]
    v_pk_mul_f32 v[102:103], v[100:101], v[30:31] op_sel:[0,0] op_sel_hi:[0,1]
    v_pk_mul_f32 v[88:89], v[86:87], v[26:27] op_sel:[0,0] op_sel_hi:[0,1]
    v_cvt_pk_bf16_f32 v120, v100, v96
    v_pk_fma_f32 v[62:63], v[54:55], v[22:23], v[62:63] op_sel:[1,1,0] op_sel_hi:[1,0,1] neg_lo:[0,1,0]
    v_pk_fma_f32 v[98:99], v[96:97], v[30:31], v[98:99] op_sel:[1,1,0] op_sel_hi:[1,0,1] neg_lo:[0,1,0]
    v_pk_fma_f32 v[88:89], v[86:87], v[26:27], v[88:89] op_sel:[1,1,0] op_sel_hi:[1,0,1] neg_lo:[0,1,0]
    v_pk_fma_f32 v[102:103], v[100:101], v[30:31], v[102:103] op_sel:[1,1,0] op_sel_hi:[1,0,1] neg_lo:[0,1,0]
    v_pk_mul_f32 v[64:65], v[44:45], v[28:29] op_sel:[0,0] op_sel_hi:[0,1]
    v_cvt_pk_bf16_f32 v136, v101, v97
    v_pk_mul_f32 v[90:91], v[88:89], v[26:27] op_sel:[0,0] op_sel_hi:[0,1]
    v_pk_mul_f32 v[96:97], v[98:99], v[30:31] op_sel:[0,0] op_sel_hi:[0,1]
    v_pk_fma_f32 v[64:65], v[44:45], v[28:29], v[64:65] op_sel:[1,1,0] op_sel_hi:[1,0,1] neg_lo:[0,1,0]
    v_pk_mul_f32 v[100:101], v[102:103], v[30:31] op_sel:[0,0] op_sel_hi:[0,1]
    v_pk_fma_f32 v[90:91], v[88:89], v[26:27], v[90:91] op_sel:[1,1,0] op_sel_hi:[1,0,1] neg_lo:[0,1,0]
    v_cvt_pk_bf16_f32 v119, v102, v98
    v_pk_mul_f32 v[66:67], v[64:65], v[28:29] op_sel:[0,0] op_sel_hi:[0,1]
    v_pk_fma_f32 v[96:97], v[98:99], v[30:31], v[96:97] op_sel:[1,1,0] op_sel_hi:[1,0,1] neg_lo:[0,1,0]
    v_pk_mul_f32 v[92:93], v[46:47], v[28:29] op_sel:[0,0] op_sel_hi:[0,1]
    v_pk_fma_f32 v[100:101], v[102:103], v[30:31], v[100:101] op_sel:[1,1,0] op_sel_hi:[1,0,1] neg_lo:[0,1,0]
    v_pk_fma_f32 v[66:67], v[64:65], v[28:29], v[66:67] op_sel:[1,1,0] op_sel_hi:[1,0,1] neg_lo:[0,1,0]
    v_cvt_pk_bf16_f32 v135, v103, v99
    v_pk_fma_f32 v[92:93], v[46:47], v[28:29], v[92:93] op_sel:[1,1,0] op_sel_hi:[1,0,1] neg_lo:[0,1,0]
    v_pk_mul_f32 v[98:99], v[96:97], v[30:31] op_sel:[0,0] op_sel_hi:[0,1]
    v_pk_mul_f32 v[8:9], v[66:67], v[28:29] op_sel:[0,0] op_sel_hi:[0,1]
    v_pk_mul_f32 v[102:103], v[100:101], v[30:31] op_sel:[0,0] op_sel_hi:[0,1]
    v_pk_mul_f32 v[94:95], v[92:93], v[28:29] op_sel:[0,0] op_sel_hi:[0,1]
    v_cvt_pk_bf16_f32 v118, v100, v96
    v_pk_fma_f32 v[8:9], v[66:67], v[28:29], v[8:9] op_sel:[1,1,0] op_sel_hi:[1,0,1] neg_lo:[0,1,0]
    v_pk_fma_f32 v[98:99], v[96:97], v[30:31], v[98:99] op_sel:[1,1,0] op_sel_hi:[1,0,1] neg_lo:[0,1,0]
    v_pk_fma_f32 v[94:95], v[92:93], v[28:29], v[94:95] op_sel:[1,1,0] op_sel_hi:[1,0,1] neg_lo:[0,1,0]
    v_pk_fma_f32 v[102:103], v[100:101], v[30:31], v[102:103] op_sel:[1,1,0] op_sel_hi:[1,0,1] neg_lo:[0,1,0]
    v_pk_mul_f32 v[10:11], v[94:95], v[28:29] op_sel:[0,0] op_sel_hi:[0,1]
    v_cvt_pk_bf16_f32 v134, v101, v97
    v_pk_fma_f32 v[10:11], v[94:95], v[28:29], v[10:11] op_sel:[1,1,0] op_sel_hi:[1,0,1] neg_lo:[0,1,0]
    v_pk_mul_f32 v[96:97], v[98:99], v[30:31] op_sel:[0,0] op_sel_hi:[0,1]
    v_pk_mul_f32 v[100:101], v[102:103], v[30:31] op_sel:[0,0] op_sel_hi:[0,1]
    v_cvt_pk_bf16_f32 v117, v102, v98
    v_pk_fma_f32 v[96:97], v[98:99], v[30:31], v[96:97] op_sel:[1,1,0] op_sel_hi:[1,0,1] neg_lo:[0,1,0]
    v_pk_fma_f32 v[100:101], v[102:103], v[30:31], v[100:101] op_sel:[1,1,0] op_sel_hi:[1,0,1] neg_lo:[0,1,0]
    v_cvt_pk_bf16_f32 v133, v103, v99
    v_pk_mul_f32 v[98:99], v[96:97], v[30:31] op_sel:[0,0] op_sel_hi:[0,1]
    v_pk_mul_f32 v[102:103], v[100:101], v[30:31] op_sel:[0,0] op_sel_hi:[0,1]
    v_cvt_pk_bf16_f32 v116, v100, v96
    v_pk_fma_f32 v[98:99], v[96:97], v[30:31], v[98:99] op_sel:[1,1,0] op_sel_hi:[1,0,1] neg_lo:[0,1,0]
    v_pk_fma_f32 v[102:103], v[100:101], v[30:31], v[102:103] op_sel:[1,1,0] op_sel_hi:[1,0,1] neg_lo:[0,1,0]
    v_cvt_pk_bf16_f32 v132, v101, v97
    v_pk_mul_f32 v[96:97], v[98:99], v[30:31] op_sel:[0,0] op_sel_hi:[0,1]
    v_pk_mul_f32 v[100:101], v[102:103], v[30:31] op_sel:[0,0] op_sel_hi:[0,1]
    v_cvt_pk_bf16_f32 v115, v102, v98
    v_pk_fma_f32 v[96:97], v[98:99], v[30:31], v[96:97] op_sel:[1,1,0] op_sel_hi:[1,0,1] neg_lo:[0,1,0]
    v_pk_fma_f32 v[100:101], v[102:103], v[30:31], v[100:101] op_sel:[1,1,0] op_sel_hi:[1,0,1] neg_lo:[0,1,0]
    v_cvt_pk_bf16_f32 v131, v103, v99
    v_pk_mul_f32 v[98:99], v[96:97], v[30:31] op_sel:[0,0] op_sel_hi:[0,1]
    v_pk_mul_f32 v[102:103], v[100:101], v[30:31] op_sel:[0,0] op_sel_hi:[0,1]
    v_cvt_pk_bf16_f32 v114, v100, v96
    v_pk_fma_f32 v[98:99], v[96:97], v[30:31], v[98:99] op_sel:[1,1,0] op_sel_hi:[1,0,1] neg_lo:[0,1,0]
    v_pk_fma_f32 v[102:103], v[100:101], v[30:31], v[102:103] op_sel:[1,1,0] op_sel_hi:[1,0,1] neg_lo:[0,1,0]
    v_cvt_pk_bf16_f32 v130, v101, v97
    v_pk_mul_f32 v[96:97], v[98:99], v[30:31] op_sel:[0,0] op_sel_hi:[0,1]
    v_pk_mul_f32 v[100:101], v[102:103], v[30:31] op_sel:[0,0] op_sel_hi:[0,1]
    v_cvt_pk_bf16_f32 v113, v102, v98
    v_pk_fma_f32 v[96:97], v[98:99], v[30:31], v[96:97] op_sel:[1,1,0] op_sel_hi:[1,0,1] neg_lo:[0,1,0]
    v_pk_fma_f32 v[100:101], v[102:103], v[30:31], v[100:101] op_sel:[1,1,0] op_sel_hi:[1,0,1] neg_lo:[0,1,0]
    v_cvt_pk_bf16_f32 v129, v103, v99
    v_cvt_pk_bf16_f32 v112, v100, v96
    v_cvt_pk_bf16_f32 v128, v101, v97
    v_cvt_pk_bf16_f32 v144, v40, v68
    v_cvt_pk_bf16_f32 v96, -v41, -v69
    v_cvt_pk_bf16_f32 v145, v70, v72
    v_cvt_pk_bf16_f32 v97, -v71, -v73
    v_cvt_pk_bf16_f32 v146, v74, v76
    v_cvt_pk_bf16_f32 v98, -v75, -v77
    v_cvt_pk_bf16_f32 v147, v78, v80
    v_cvt_pk_bf16_f32 v99, -v79, -v81
    v_cvt_pk_bf16_f32 v148, v42, v84
    v_cvt_pk_bf16_f32 v100, -v43, -v85
    v_cvt_pk_bf16_f32 v149, v86, v74
    v_cvt_pk_bf16_f32 v101, -v87, -v75
    v_cvt_pk_bf16_f32 v150, v86, v88
    v_cvt_pk_bf16_f32 v102, -v87, -v89
    v_cvt_pk_bf16_f32 v151, v90, v82
    v_cvt_pk_bf16_f32 v103, -v91, -v83
    v_cvt_pk_bf16_f32 v152, v44, v64
    v_cvt_pk_bf16_f32 v104, -v45, -v65
    v_cvt_pk_bf16_f32 v153, v66, v8
    v_cvt_pk_bf16_f32 v105, -v67, -v9
    v_cvt_pk_bf16_f32 v154, v46, v92
    v_cvt_pk_bf16_f32 v106, -v47, -v93
    v_cvt_pk_bf16_f32 v155, v94, v10
    v_cvt_pk_bf16_f32 v107, -v95, -v11
    v_cvt_pk_bf16_f32 v156, v48, v56
    v_cvt_pk_bf16_f32 v108, -v49, -v57
    v_cvt_pk_bf16_f32 v157, v50, v58
    v_cvt_pk_bf16_f32 v109, -v51, -v59
    v_cvt_pk_bf16_f32 v158, v52, v60
    v_cvt_pk_bf16_f32 v110, -v53, -v61
    v_cvt_pk_bf16_f32 v159, v54, v62
    v_cvt_pk_bf16_f32 v111, -v55, -v63
    s_mov_b32 s64, 0xff
    s_mov_b32 s65, 0xff0000
    v_cndmask_b32 v88, 0, v160, s[64:65]
    v_cndmask_b32 v89, 0, v161, s[64:65]
    v_cndmask_b32 v90, 0, v162, s[64:65]
    v_cndmask_b32 v91, 0, v163, s[64:65]
    s_mov_b32 s64, 0xff00
    s_mov_b32 s65, 0xff000000
    v_cndmask_b32 v92, 0, v160, s[64:65]
    v_cndmask_b32 v93, 0, v161, s[64:65]
    v_cndmask_b32 v94, 0, v162, s[64:65]
    v_cndmask_b32 v95, 0, v163, s[64:65]
    s_load_dword s52, s[32:33], 0
    s_nop 0
    v_mfma_f32_32x32x16_bf16 v[40:55], v[112:115], v[88:91], 0
    v_mfma_f32_32x32x16_bf16 v[40:55], v[116:119], v[92:95], v[40:55]
    v_mfma_f32_32x32x16_bf16 v[56:71], v[120:123], v[88:91], 0
    v_mfma_f32_32x32x16_bf16 v[56:71], v[124:127], v[92:95], v[56:71]
    v_mfma_f32_32x32x16_bf16 v[72:87], v[144:147], v[88:91], 0
    v_mfma_f32_32x32x16_bf16 v[72:87], v[148:151], v[92:95], v[72:87]
    s_nop 7
    v_cvt_pk_bf16_f32 v112, v40, v41
    v_cvt_pk_bf16_f32 v113, v42, v43
    v_cvt_pk_bf16_f32 v114, v44, v45
    v_cvt_pk_bf16_f32 v115, v46, v47
    v_cvt_pk_bf16_f32 v116, v48, v49
    v_cvt_pk_bf16_f32 v117, v50, v51
    v_cvt_pk_bf16_f32 v118, v52, v53
    v_cvt_pk_bf16_f32 v119, v54, v55
    v_mfma_f32_32x32x16_bf16 v[40:55], v[152:155], v[88:91], 0
    s_nop 0
    v_cvt_pk_bf16_f32 v120, v56, v57
    v_cvt_pk_bf16_f32 v121, v58, v59
    v_cvt_pk_bf16_f32 v122, v60, v61
    v_cvt_pk_bf16_f32 v123, v62, v63
    v_mfma_f32_32x32x16_bf16 v[40:55], v[156:159], v[92:95], v[40:55]
    v_cvt_pk_bf16_f32 v124, v64, v65
    v_cvt_pk_bf16_f32 v125, v66, v67
    v_cvt_pk_bf16_f32 v126, v68, v69
    v_cvt_pk_bf16_f32 v127, v70, v71
    v_mfma_f32_32x32x16_bf16 v[56:71], v[128:131], v[88:91], 0
    v_cvt_pk_bf16_f32 v144, v72, v73
    v_cvt_pk_bf16_f32 v145, v74, v75
    v_cvt_pk_bf16_f32 v146, v76, v77
    v_cvt_pk_bf16_f32 v147, v78, v79
    v_cvt_pk_bf16_f32 v148, v80, v81
    v_cvt_pk_bf16_f32 v149, v82, v83
    v_cvt_pk_bf16_f32 v150, v84, v85
    v_cvt_pk_bf16_f32 v151, v86, v87
    v_mfma_f32_32x32x16_bf16 v[56:71], v[132:135], v[92:95], v[56:71]
    v_permlane16_swap_b32 v112, v120
    v_permlane16_swap_b32 v113, v121
    v_permlane16_swap_b32 v114, v122
    v_permlane16_swap_b32 v115, v123
    v_permlane16_swap_b32 v116, v124
    v_permlane16_swap_b32 v117, v125
    v_permlane16_swap_b32 v118, v126
    v_permlane16_swap_b32 v119, v127
    v_mfma_f32_32x32x16_bf16 v[72:87], v[136:139], v[88:91], 0
    v_cvt_pk_bf16_f32 v152, v40, v41
    v_cvt_pk_bf16_f32 v153, v42, v43
    v_cvt_pk_bf16_f32 v154, v44, v45
    v_cvt_pk_bf16_f32 v155, v46, v47
    v_mfma_f32_32x32x16_bf16 v[72:87], v[140:143], v[92:95], v[72:87]
    v_cvt_pk_bf16_f32 v156, v48, v49
    v_cvt_pk_bf16_f32 v157, v50, v51
    v_cvt_pk_bf16_f32 v158, v52, v53
    v_cvt_pk_bf16_f32 v159, v54, v55
    v_mfma_f32_32x32x16_bf16 v[40:55], v[96:99], v[88:91], 0
    v_cvt_pk_bf16_f32 v128, v56, v57
    v_cvt_pk_bf16_f32 v129, v58, v59
    v_cvt_pk_bf16_f32 v130, v60, v61
    v_cvt_pk_bf16_f32 v131, v62, v63
    v_cvt_pk_bf16_f32 v132, v64, v65
    v_cvt_pk_bf16_f32 v133, v66, v67
    v_cvt_pk_bf16_f32 v134, v68, v69
    v_cvt_pk_bf16_f32 v135, v70, v71
    v_mfma_f32_32x32x16_bf16 v[40:55], v[100:103], v[92:95], v[40:55]
    v_permlane16_swap_b32 v144, v152
    v_permlane16_swap_b32 v145, v153
    v_permlane16_swap_b32 v146, v154
    v_permlane16_swap_b32 v147, v155
    v_permlane16_swap_b32 v148, v156
    v_permlane16_swap_b32 v149, v157
    v_permlane16_swap_b32 v150, v158
    v_permlane16_swap_b32 v151, v159
    v_mfma_f32_32x32x16_bf16 v[56:71], v[104:107], v[88:91], 0
    v_cvt_pk_bf16_f32 v136, v72, v73
    v_cvt_pk_bf16_f32 v137, v74, v75
    v_cvt_pk_bf16_f32 v138, v76, v77
    v_cvt_pk_bf16_f32 v139, v78, v79
    v_mfma_f32_32x32x16_bf16 v[56:71], v[108:111], v[92:95], v[56:71]
    v_cvt_pk_bf16_f32 v140, v80, v81
    v_cvt_pk_bf16_f32 v141, v82, v83
    v_cvt_pk_bf16_f32 v142, v84, v85
    v_cvt_pk_bf16_f32 v143, v86, v87
    v_mfma_f32_32x32x16_bf16 v[20:35], v[144:147], v[112:115], 0
    v_cvt_pk_bf16_f32 v96, v40, v41
    v_cvt_pk_bf16_f32 v97, v42, v43
    v_cvt_pk_bf16_f32 v98, v44, v45
    v_cvt_pk_bf16_f32 v99, v46, v47
    v_cvt_pk_bf16_f32 v100, v48, v49
    v_cvt_pk_bf16_f32 v101, v50, v51
    v_mfma_f32_32x32x16_bf16 v[20:35], v[148:151], v[116:119], v[20:35]
    v_cvt_pk_bf16_f32 v102, v52, v53
    v_cvt_pk_bf16_f32 v103, v54, v55
    v_permlane16_swap_b32 v128, v136
    v_permlane16_swap_b32 v129, v137
    v_permlane16_swap_b32 v130, v138
    v_permlane16_swap_b32 v131, v139
    v_mfma_f32_32x32x16_bf16 v[20:35], v[152:155], v[120:123], v[20:35]
    v_permlane16_swap_b32 v132, v140
    v_permlane16_swap_b32 v133, v141
    v_permlane16_swap_b32 v134, v142
    v_permlane16_swap_b32 v135, v143
    v_cvt_pk_bf16_f32 v104, v56, v57
    v_cvt_pk_bf16_f32 v105, v58, v59
    v_mfma_f32_32x32x16_bf16 v[20:35], v[156:159], v[124:127], v[20:35]
    v_cvt_pk_bf16_f32 v106, v60, v61
    v_cvt_pk_bf16_f32 v107, v62, v63
    v_cvt_pk_bf16_f32 v108, v64, v65
    v_cvt_pk_bf16_f32 v109, v66, v67
    v_cvt_pk_bf16_f32 v110, v68, v69
    v_cvt_pk_bf16_f32 v111, v70, v71
    s_nop 1
    v_permlane16_swap_b32 v96, v104
    v_permlane16_swap_b32 v97, v105
    v_permlane16_swap_b32 v98, v106
    v_permlane16_swap_b32 v99, v107
    v_permlane16_swap_b32 v100, v108
    v_permlane16_swap_b32 v101, v109
    v_permlane16_swap_b32 v102, v110
    v_permlane16_swap_b32 v103, v111
    s_nop 1
    v_mfma_f32_32x32x16_bf16 v[20:35], v[96:99], v[128:131], v[20:35]
    v_mfma_f32_32x32x16_bf16 v[20:35], v[100:103], v[132:135], v[20:35]
    v_mfma_f32_32x32x16_bf16 v[20:35], v[104:107], v[136:139], v[20:35]
    v_mfma_f32_32x32x16_bf16 v[20:35], v[108:111], v[140:143], v[20:35]
    v_lshlrev_b32 v157, 2, v7
    v_lshlrev_b32 v156, 2, s50
    v_mov_b32 v154, 0x7ffffff0
    v_add_u32 v17, s58, v16
    s_cmp_eq_u32 s61, s62
    s_nop 6
    s_cbranch_scc1 KA_X0
    v_swap_b32 v20, v28
    v_swap_b32 v21, v29
    v_swap_b32 v22, v30
    v_swap_b32 v23, v31
    v_swap_b32 v24, v32
    v_swap_b32 v25, v33
    v_swap_b32 v26, v34
    v_swap_b32 v27, v35
KA_X0:
    ds_write_b128 v16, v[28:31]
    ds_write_b128 v16, v[32:35] offset:1024
    s_barrier
    s_mov_b32 s20, 0x49024902
    s_mov_b32 s21, 0x24009000
    v_mov_b32 v96, 0xcccc
    v_mov_b32 v97, 0xcccc
    v_add_u32 v8, 16, v7
    v_and_b32 v8, 15, v8
    v_lshlrev_b32 v8, 1, v8
    v_bfe_u32 v9, s20, v8, 2
    v_bfe_u32 v10, s21, v8, 2
    v_lshl_or_b32 v96, v9, 0, v96
    v_lshl_or_b32 v97, v10, 0, v97
    v_add_u32 v8, 12, v7
    v_and_b32 v8, 15, v8
    v_lshlrev_b32 v8, 1, v8
    v_bfe_u32 v9, s20, v8, 2
    v_bfe_u32 v10, s21, v8, 2
    v_lshl_or_b32 v96, v9, 4, v96
    v_lshl_or_b32 v97, v10, 4, v97
    v_add_u32 v8, 8, v7
    s_barrier
    v_and_b32 v8, 15, v8
    v_lshlrev_b32 v8, 1, v8
    v_bfe_u32 v9, s20, v8, 2
    v_bfe_u32 v10, s21, v8, 2
    v_lshl_or_b32 v96, v9, 8, v96
    v_lshl_or_b32 v97, v10, 8, v97
    v_add_u32 v8, 4, v7
    v_and_b32 v8, 15, v8
    v_lshlrev_b32 v8, 1, v8
    v_bfe_u32 v9, s20, v8, 2
    v_bfe_u32 v10, s21, v8, 2
    v_lshl_or_b32 v96, v9, 12, v96
    v_lshl_or_b32 v97, v10, 12, v97
    v_lshlrev_b32 v8, 4, v3
    v_sub_u32 v8, v7, v8
    v_add_u32 v8, 3, v8
    v_max_i32 v8, 0, v8
    v_and_b32 v8, 0x3c, v8
    v_min_u32 v8, 16, v8
    s_barrier
    s_lshl_b32 s22, s61, 4
    v_max_u32 v8, s22, v8
    v_lshlrev_b32 v8, v8, -1
    v_bfi_b32 v98, v8, v96, v97
    v_and_b32 v8, 3, v7
    v_mul_u32_u24 v9, 8384, v8
    v_lshrrev_b32 v8, 1, v8
    v_lshl_add_u32 v9, v8, 5, v9
    v_and_b32 v8, 28, v7
    v_sub_u32 v9, v9, v8
    v_lshl_add_u32 v9, v3, 4, v9
    s_mul_i32 s22, s62, 4160
    s_lshl_b32 s23, s61, 5
    s_sub_u32 s22, s22, s23
    s_add_u32 s22, s22, 20160
    v_add_u32 v99, s22, v9
    v_add_u32 v110, 11952, v39
    s_barrier
    s_waitcnt lgkmcnt(0)
    s_cmp_lg_u32 s52, 0
    s_cbranch_scc1 KA_TK21
    v_mov_b32 v155, 0
    s_mov_b32 s69, 20000
KA_TL20:
    global_load_dword v158, v155, s[32:33] sc1
    s_waitcnt vmcnt(0)
    v_readfirstlane_b32 s52, v158
    s_cmp_lg_u32 s52, 0
    s_cbranch_scc1 KA_TK21
    s_sub_u32 s69, s69, 1
    s_cbranch_scc0 KA_TL20
    s_mov_b32 s52, 1
KA_TK21:
    s_getreg_b32 s66, hwreg(HW_REG_XCC_ID)
    s_and_b32 s66, s66, 15
    s_add_u32 s66, s66, 1
    s_lshl_b32 s66, s66, 1
    s_xor_b32 s66, s66, s52
    s_add_u32 s67, s51, 786432
    s_cmp_lg_u32 s54, 0
    s_cbranch_scc1 KA_NPB
    v_mov_b32 v155, s66
    s_mov_b64 exec, 1
    buffer_store_dword v155, v156, s[44:47], s67 offen
    s_mov_b64 exec, -1
KA_NPB:
    s_barrier
    s_barrier
    v_lshrrev_b32 v8, 3, v1
    v_bfe_u32 v9, v1, 4, 1
    v_lshlrev_b32 v9, 2, v9
    v_and_b32 v10, 7, v1
    v_xor_b32 v9, v9, v10
    v_lshlrev_b32 v9, 4, v9
    v_lshl_add_u32 v144, v8, 10, v9
    v_add_u32 v145, 7168, v144
    v_add_u32 v146, 14336, v144
    v_add_u32 v147, 21504, v144
    v_lshlrev_b32 v150, 7, v10
    v_lshlrev_b32 v148, 3, v7
    v_lshlrev_b32 v109, 12, v8
    v_lshl_add_u32 v109, v10, 4, v109
    s_lshl_b32 s63, s62, 12
    s_lshl_b32 s64, s61, 4
    s_add_u32 s63, s63, s64
    s_barrier
    s_add_u32 s63, s63, 83968
    v_lshl_add_u32 v149, v7, 7, s63
    v_lshl_add_u32 v149, v3, 5, v149
    v_lshlrev_b32 v153, 10, v7
    v_lshl_add_u32 v153, v3, 4, v153
    s_lshl_b32 s63, s54, 11
    s_add_u32 s63, s63, 98304
    v_add_u32 v151, s63, v4
    v_lshrrev_b32 v8, 1, v7
    v_lshl_add_u32 v108, v8, 7, s63
    v_lshl_add_u32 v108, v3, 5, v108
    v_and_b32 v8, 1, v7
    v_lshl_add_u32 v108, v8, 4, v108
    v_bfe_u32 v8, v1, 2, 2
    v_lshl_add_u32 v152, v3, 2, v8
    v_lshlrev_b32 v152, 7, v152
    v_lshrrev_b32 v8, 1, v8
    s_barrier
    v_xor_b32 v8, s62, v8
    v_lshl_add_u32 v152, v8, 6, v152
    v_bfe_u32 v8, v1, 4, 1
    v_lshl_add_u32 v152, v8, 5, v152
    v_and_b32 v8, 3, v1
    v_lshl_add_u32 v152, v8, 3, v152
    v_add_u32 v152, 18432, v152
    v_lshrrev_b32 v8, 3, v7
    v_bfe_u32 v9, v7, 1, 1
    v_lshl_add_u32 v8, v8, 1, v9
    v_bfe_u32 v9, v7, 2, 1
    v_xor_b32 v9, v9, v3
    v_lshl_add_u32 v8, v9, 3, v8
    v_and_b32 v9, 1, v7
    v_lshlrev_b32 v9, 4, v9
    v_mov_b32 v10, 0xffff
    v_lshlrev_b32 v9, v9, v10
    s_waitcnt lgkmcnt(0)
    s_barrier
    ds_read_b128 v[28:31], v17
    ds_read_b128 v[32:35], v17 offset:1024
    v_cmp_eq_u32 s[4:5], 0, v8
    v_cmp_eq_u32 s[6:7], 1, v8
    v_cmp_eq_u32 s[8:9], 2, v8
    v_cmp_eq_u32 s[10:11], 3, v8
    v_cmp_eq_u32 s[12:13], 4, v8
    v_cmp_eq_u32 s[14:15], 5, v8
    v_cmp_eq_u32 s[16:17], 6, v8
    v_cmp_eq_u32 s[18:19], 7, v8
    s_nop 0
    v_cndmask_b32 v100, 0, v9, s[4:5]
    v_cndmask_b32 v101, 0, v9, s[6:7]
    v_cndmask_b32 v102, 0, v9, s[8:9]
    v_cndmask_b32 v103, 0, v9, s[10:11]
    v_cndmask_b32 v104, 0, v9, s[12:13]
    v_cndmask_b32 v105, 0, v9, s[14:15]
    v_cndmask_b32 v106, 0, v9, s[16:17]
    v_cndmask_b32 v107, 0, v9, s[18:19]
    s_barrier
    buffer_load_dword v158, v157, s[44:47], s67 offen sc1
    s_waitcnt lgkmcnt(0)
    v_add_f32 v20, v20, v28
    v_add_f32 v21, v21, v29
    v_add_f32 v22, v22, v30
    v_add_f32 v23, v23, v31
    v_add_f32 v24, v24, v32
    v_add_f32 v25, v25, v33
    v_add_f32 v26, v26, v34
    v_add_f32 v27, v27, v35
    s_cmp_eq_u32 s61, s62
    s_cbranch_scc0 KA_X1
    s_barrier
    v_cmp_eq_u32 s[72:73], 31, v1
    v_lshlrev_b32 v8, 3, v3
    v_xor_b32 v8, 8, v8
    v_cndmask_b32 v9, 0, v15, s[72:73]
    v_add_u32 v18, v19, v8
    v_add_f32 v20, v20, v9
    v_add_u32 v36, 11460, v18
    v_add_u32 v37, 19844, v18
    v_cvt_pk_bf16_f32 v40, v23, v22
    v_cvt_pk_bf16_f32 v41, v21, v20
    v_cvt_pk_bf16_f32 v42, v26, v25
    v_cvt_pk_bf16_f32 v43, v24, v24
    v_cvt_pk_bf16_f32 v44, v27, v23
    s_barrier
    v_cvt_pk_bf16_f32 v45, v22, v21
    v_cvt_pk_bf16_f32 v46, v26, v26
    v_cvt_pk_bf16_f32 v47, v25, v24
    v_lshrrev_b32 v9, 16, v41
    v_mov_b32 v112, 0
    v_mov_b32 v113, 0
    v_mov_b32 v114, 0
    v_mov_b32 v115, 0
    v_mov_b32 v116, 0
    v_mov_b32 v117, 0
    v_mov_b32 v118, 0
    v_mov_b32 v119, 0
    v_mov_b32 v120, 0
    s_barrier
    s_waitcnt vmcnt(0)
    v_cmp_ne_u32 vcc, s66, v158
    s_mov_b32 s59, 1
    s_cbranch_vccnz KA_UE22
    s_mov_b32 s59, 0
    s_mov_b32 m0, s75
    s_cmp_lg_u32 s54, 0
    buffer_load_dwordx4 v2, s[44:47], s74 offen lds
    s_cbranch_scc1 KA_UL23
    s_add_u32 m0, s75, 8192
    s_nop 0
    buffer_load_dwordx4 v6, s[44:47], s74 offen lds
KA_UL23:
    s_add_u32 m0, s75, 4096
    s_nop 0
    buffer_load_dwordx4 v5, s[44:47], s74 offen lds
    s_mov_b32 m0, s60
    s_mov_b64 exec, 1
    buffer_load_dword v154, s[44:47], 0 offen lds
    s_mov_b64 exec, -1
KA_UE22:
    s_barrier
    v_mov_b32 v121, 0
    v_mov_b32 v122, 0
    v_mov_b32 v123, 0
    v_mov_b32 v124, 0
    v_mov_b32 v125, 0
    v_mov_b32 v126, 0
    v_mov_b32 v127, 0
    v_mov_b32 v128, 0
    v_mov_b32 v129, 0
    v_mov_b32 v130, 0
    v_mov_b32 v131, 0
    v_mov_b32 v132, 0
    v_mov_b32 v133, 0
    s_barrier
    v_mov_b32 v134, 0
    v_mov_b32 v135, 0
    v_mov_b32 v136, 0
    v_mov_b32 v137, 0
    v_mov_b32 v138, 0
    v_mov_b32 v139, 0
    v_mov_b32 v140, 0
    v_mov_b32 v141, 0
    v_mov_b32 v142, 0
    v_mov_b32 v143, 0
    s_barrier
    ds_write_b64 v18, v[44:45] offset:3584
    ds_write_b64 v18, v[46:47] offset:3072
    ds_write2_b32 v36, v40, v41 offset0:128 offset1:129
    ds_write2_b32 v36, v42, v43 offset0:0 offset1:1
    ds_write2_b32 v37, v44, v45 offset0:128 offset1:129
    ds_write2_b32 v37, v46, v47 offset0:0 offset1:1
    ds_write_b64 v18, v[40:41] offset:28744
    ds_write_b64 v18, v[42:43] offset:28232
    s_mov_b64 exec, s[72:73]
    ds_write_b32 v18, v9 offset:3592
    ds_write_b32 v37, v9 offset:520
    s_branch KA_XD
KA_X1:
    s_barrier
    v_and_b32 v8, 1, v1
    v_cmp_eq_u32 s[72:73], 1, v8
    v_lshlrev_b32 v8, 3, v7
    v_sub_u32 v18, v19, v8
    v_lshlrev_b32 v8, 8, v3
    v_cndmask_b32 v36, v25, v24, s[72:73]
    v_cndmask_b32 v37, v27, v26, s[72:73]
    v_sub_u32 v18, v18, v8
    v_sub_u32 v17, v18, v8
    v_add_u32 v80, 1280, v18
    v_add_u32 v84, 512, v17
    v_add_u32 v81, 9664, v18
    v_add_u32 v85, 8896, v17
    v_add_u32 v82, 18080, v18
    v_add_u32 v86, 17312, v17
    s_barrier
    v_add_u32 v83, 26468, v18
    v_add_u32 v87, 25700, v17
    v_cvt_pk_bf16_f32 v8, v21, v20
    v_cvt_pk_bf16_f32 v9, v20, v20
    v_mov_b32 v12, s52
    v_cvt_pk_bf16_f32 v48, v22, v22
    v_cvt_pk_bf16_f32 v49, v22, v21
    v_cvt_pk_bf16_f32 v50, v21, v21
    v_cvt_pk_bf16_f32 v51, v20, v20
    v_cvt_pk_bf16_f32 v52, v22, v22
    v_cvt_pk_bf16_f32 v53, v22, v22
    v_cvt_pk_bf16_f32 v54, v21, v21
    v_cvt_pk_bf16_f32 v55, v21, v20
    v_cvt_pk_bf16_f32 v56, v22, v22
    v_cvt_pk_bf16_f32 v57, v22, v22
    s_barrier
    s_waitcnt vmcnt(0)
    v_cmp_ne_u32 vcc, s66, v158
    s_mov_b32 s59, 1
    s_cbranch_vccnz KA_UE24
    s_mov_b32 s59, 0
    s_mov_b32 m0, s75
    s_cmp_lg_u32 s54, 0
    buffer_load_dwordx4 v2, s[44:47], s74 offen lds
    s_cbranch_scc1 KA_UL25
    s_add_u32 m0, s75, 8192
    s_nop 0
    buffer_load_dwordx4 v6, s[44:47], s74 offen lds
KA_UL25:
    s_add_u32 m0, s75, 4096
    s_nop 0
    buffer_load_dwordx4 v5, s[44:47], s74 offen lds
    s_mov_b32 m0, s60
    s_mov_b64 exec, 1
    buffer_load_dword v154, s[44:47], 0 offen lds
    s_mov_b64 exec, -1
KA_UE24:
    s_barrier
    v_cvt_pk_bf16_f32 v58, v22, v21
    v_cvt_pk_bf16_f32 v59, v21, v21
    v_cvt_pk_bf16_f32 v60, v23, v22
    v_cvt_pk_bf16_f32 v61, v22, v22
    v_cvt_pk_bf16_f32 v62, v22, v22
    v_cvt_pk_bf16_f32 v63, v21, v21
    v_sub_f32 v10, v21, v20
    v_sub_f32 v11, v22, v21
    v_cvt_pk_bf16_f32 v64, v10, v20
    v_cvt_pk_bf16_f32 v65, v11, v21
    v_cvt_pk_bf16_f32 v66, 0, v22
    v_sub_f32 v10, v36, v24
    v_sub_f32 v11, v25, v24
    v_sub_f32 v13, v25, v36
    v_cvt_pk_bf16_f32 v68, 0, v24
    s_barrier
    v_cvt_pk_bf16_f32 v69, v10, v24
    v_cvt_pk_bf16_f32 v70, v11, v24
    v_cvt_pk_bf16_f32 v71, v13, v36
    v_cvt_pk_bf16_f32 v72, 0, v25
    v_sub_f32 v10, v37, v26
    v_sub_f32 v11, v27, v26
    v_sub_f32 v13, v27, v37
    v_cvt_pk_bf16_f32 v74, 0, v26
    v_cvt_pk_bf16_f32 v75, v10, v26
    v_cvt_pk_bf16_f32 v76, v11, v26
    v_cvt_pk_bf16_f32 v77, v13, v37
    v_cvt_pk_bf16_f32 v78, 0, v27
    s_barrier
    s_mov_b32 exec_lo, 0x80000000
    s_mov_b32 exec_hi, 0
    ds_write_b32 v164, v12 offset:108
    ds_write_b32 v19, v9 offset:10960
    ds_write_b32 v19, v9 offset:19344
    ds_write_b64 v19, v[8:9] offset:27728
    s_mov_b32 exec_lo, 0xff000000
    ds_write_b128 v19, v[48:51] offset:2560
    ds_write_b128 v19, v[52:55] offset:10944
    ds_write_b128 v19, v[56:59] offset:19328
    ds_write_b128 v19, v[60:63] offset:27712
    s_mov_b64 exec, -1
    ds_write2_b32 v80, v65, v64 offset0:0 offset1:1
    ds_write2_b32 v81, v66, v64 offset0:0 offset1:1
    ds_write2_b32 v82, v66, v65 offset0:0 offset1:1
    ds_write2_b32 v83, v65, v64 offset0:0 offset1:1
    ds_write2_b32 v84, v72, v69 offset0:64 offset1:65
    ds_write2_b32 v85, v72, v70 offset0:64 offset1:65
    ds_write2_b32 v86, v72, v70 offset0:64 offset1:65
    ds_write2_b32 v87, v71, v68 offset0:64 offset1:65
    ds_write2_b32 v84, v78, v75 offset0:0 offset1:1
    ds_write2_b32 v85, v78, v76 offset0:0 offset1:1
    ds_write2_b32 v86, v78, v76 offset0:0 offset1:1
    ds_write2_b32 v87, v77, v74 offset0:0 offset1:1
    v_mov_b32 v112, 0
    v_mov_b32 v113, 0
    v_mov_b32 v114, 0
    v_mov_b32 v115, 0
    v_mov_b32 v116, 0
    v_mov_b32 v117, 0
    v_mov_b32 v118, 0
    v_mov_b32 v119, 0
    v_mov_b32 v120, 0
    v_mov_b32 v121, 0
    v_mov_b32 v122, 0
    v_mov_b32 v123, 0
    v_mov_b32 v124, 0
    v_mov_b32 v125, 0
    v_mov_b32 v126, 0
    v_mov_b32 v127, 0
    v_mov_b32 v128, 0
    v_mov_b32 v129, 0
    v_mov_b32 v130, 0
    v_mov_b32 v131, 0
    v_mov_b32 v132, 0
    v_mov_b32 v133, 0
    v_mov_b32 v134, 0
    v_mov_b32 v135, 0
    v_mov_b32 v136, 0
    v_mov_b32 v137, 0
    v_mov_b32 v138, 0
    v_mov_b32 v139, 0
    v_mov_b32 v140, 0
    v_mov_b32 v141, 0
    v_mov_b32 v142, 0
    v_mov_b32 v143, 0
    s_mov_b64 exec, 1
KA_XD:
    ds_add_u32 v167, v165 offset:180
    s_mov_b64 exec, -1
    s_cmp_eq_u32 s59, 0
    s_cbranch_scc1 KA_UOK
    s_mov_b32 s69, 64
KA_GF26:
    buffer_load_dword v158, v157, s[44:47], s67 offen offset:0 sc1
    s_waitcnt vmcnt(0)
    v_cmp_ne_u32 vcc, s66, v158
    s_cbranch_vccz KA_GD28
    s_sub_u32 s69, s69, 1
    s_cbranch_scc0 KA_GF26
    buffer_wbl2 sc1
    s_waitcnt vmcnt(0)
    v_mov_b32 v155, s52
    s_cmp_eq_u32 s54, 0
    s_cbranch_scc0 KA_GS27N
    s_mov_b64 exec, 1
    buffer_store_dword v155, v156, s[44:47], s67 offen offset:1024 sc1
    s_mov_b64 exec, -1
KA_GS27N:
    s_mov_b32 s69, 20000
KA_GS27:
    buffer_load_dword v158, v157, s[44:47], s67 offen offset:0 sc1
    buffer_load_dword v160, v157, s[44:47], s67 offen offset:1024 sc1
    s_waitcnt vmcnt(0)
    v_cmp_ne_u32 vcc, s66, v158
    v_cmp_ne_u32 s[70:71], s52, v160
    s_and_b64 vcc, vcc, s[70:71]
    s_cbranch_scc0 KA_GD28A
    s_sleep 8
    s_sub_u32 s69, s69, 1
    s_cbranch_scc0 KA_GS27
KA_GD28A:
    buffer_inv sc1
    s_waitcnt vmcnt(0)
KA_GD28:
    s_mov_b32 m0, s75
    s_cmp_lg_u32 s54, 0
    buffer_load_dwordx4 v2, s[44:47], s74 offen lds
    s_cbranch_scc1 KA_UL29
    s_add_u32 m0, s75, 8192
    s_nop 0
    buffer_load_dwordx4 v6, s[44:47], s74 offen lds
KA_UL29:
    s_add_u32 m0, s75, 4096
    s_nop 0
    buffer_load_dwordx4 v5, s[44:47], s74 offen lds
    s_mov_b32 m0, s60
    s_mov_b64 exec, 1
    buffer_load_dword v154, s[44:47], 0 offen lds
    s_mov_b64 exec, -1
KA_UOK:
    s_mov_b32 s77, 1048576
KA_W30:
    ds_read_b128 v[160:163], v164 offset:0
    s_sub_u32 s77, s77, 1
    s_cbranch_scc1 KA_E31
    s_waitcnt lgkmcnt(0)
    v_or3_b32 v160, v160, v161, v162
    v_or_b32 v160, v160, v163
    v_cmp_ne_u32 vcc, 0, v160
    s_cbranch_vccnz KA_W30
KA_E31:
    s_mov_b32 s77, 1048576
KA_W32:
    ds_read_b32 v166, v167 offset:180
    s_sub_u32 s77, s77, 1
    s_cbranch_scc1 KA_E33
    s_waitcnt lgkmcnt(0)
    v_readfirstlane_b32 s76, v166
    s_cmp_lt_u32 s76, 3
    s_cbranch_scc1 KA_W32
KA_E33:
    ds_read_b128 v[64:67], v39 offset:5536
    ds_read_b64 v[48:49], v38 offset:416
    ds_read_b64 v[50:51], v38 offset:424
    ds_read_b128 v[80:83], v39 offset:928
    ds_read_b128 v[68:71], v39 offset:5472
    ds_read_b64 v[52:53], v38 offset:384
    ds_read_b64 v[54:55], v38 offset:392
    ds_read_b128 v[84:87], v39 offset:864
    ds_read_b128 v[72:75], v39 offset:5248
    ds_read_b64 v[56:57], v38 offset:288
    ds_read_b64 v[58:59], v38 offset:296
    ds_read_b128 v[88:91], v39 offset:640
    s_waitcnt lgkmcnt(8)
    ds_read_b128 v[76:79], v39 offset:5184
    ds_read_b64 v[60:61], v38 offset:256
    ds_read_b64 v[62:63], v38 offset:264
    ds_read_b128 v[92:95], v39 offset:576
    s_mov_b32 s63, 4
KA_CV0:
    s_waitcnt lgkmcnt(11)
    v_mfma_f32_32x32x16_bf16 v[128:143], v[48:51], v[64:67], v[128:143]
    ds_read_b128 v[64:67], v39 offset:4960
    v_mfma_f32_32x32x16_bf16 v[112:127], v[48:51], v[80:83], v[112:127]
    ds_read_b64 v[48:49], v38 offset:160
    ds_read_b64 v[50:51], v38 offset:168
    ds_read_b128 v[80:83], v39 offset:352
    s_waitcnt lgkmcnt(11)
    v_mfma_f32_32x32x16_bf16 v[128:143], v[52:55], v[68:71], v[128:143]
    ds_read_b128 v[68:71], v39 offset:4896
    v_mfma_f32_32x32x16_bf16 v[112:127], v[52:55], v[84:87], v[112:127]
    ds_read_b64 v[52:53], v38 offset:128
    ds_read_b64 v[54:55], v38 offset:136
    ds_read_b128 v[84:87], v39 offset:288
    s_waitcnt lgkmcnt(11)
    v_mfma_f32_32x32x16_bf16 v[128:143], v[56:59], v[72:75], v[128:143]
    ds_read_b128 v[72:75], v39 offset:4672
    v_mfma_f32_32x32x16_bf16 v[112:127], v[56:59], v[88:91], v[112:127]
    ds_read_b64 v[56:57], v38 offset:32
    ds_read_b64 v[58:59], v38 offset:40
    ds_read_b128 v[88:91], v39 offset:64
    s_waitcnt lgkmcnt(11)
    v_mfma_f32_32x32x16_bf16 v[128:143], v[60:63], v[76:79], v[128:143]
    ds_read_b128 v[76:79], v39 offset:4608
    v_mfma_f32_32x32x16_bf16 v[112:127], v[60:63], v[92:95], v[112:127]
    ds_read_b64 v[60:61], v38 offset:0
    ds_read_b64 v[62:63], v38 offset:8
    ds_read_b128 v[92:95], v39 offset:0
    v_subrev_u32 v38, 256, v38
    v_subrev_u32 v39, 576, v39
    s_sub_u32 s63, s63, 1
    s_cmp_lg_u32 s63, 0
    s_cbranch_scc1 KA_CV0
    s_waitcnt lgkmcnt(8)
    v_mfma_f32_32x32x16_bf16 v[128:143], v[48:51], v[64:67], v[128:143]
    v_mfma_f32_32x32x16_bf16 v[112:127], v[48:51], v[80:83], v[112:127]
    v_mfma_f32_32x32x16_bf16 v[128:143], v[52:55], v[68:71], v[128:143]
    v_mfma_f32_32x32x16_bf16 v[112:127], v[52:55], v[84:87], v[112:127]
    s_mov_b32 s77, 1048576
    s_branch KA_W34F
KA_W34:
    s_sleep 1
KA_W34F:
    ds_read_b32 v166, v164 offset:188
    s_sub_u32 s77, s77, 1
    s_cbranch_scc1 KA_E35
    s_waitcnt lgkmcnt(0)
    v_readfirstlane_b32 s76, v166
    s_cmp_lt_u32 s76, 2
    s_cbranch_scc1 KA_W34
KA_E35:
    s_mov_b32 s63, 7
KA_CV1:
    ds_read2_b32 v[40:41], v99 offset0:0 offset1:1
    ds_read2_b32 v[42:43], v99 offset0:2 offset1:3
    ds_read_b128 v[56:59], v110 offset:4608
    ds_read_b128 v[60:63], v110 offset:4672
    s_waitcnt lgkmcnt(0)
    v_smfmac_f32_32x32x32_bf16 v[128:143], v[40:43], v[56:63], v96
    ds_read_b128 v[72:75], v110 offset:0
    ds_read_b128 v[76:79], v110 offset:64
    v_subrev_u32 v99, 64, v99
    v_subrev_u32 v110, 288, v110
    s_sub_u32 s63, s63, 1
    s_cmp_lg_u32 s63, 0
    s_waitcnt lgkmcnt(0)
    v_smfmac_f32_32x32x32_bf16 v[112:127], v[40:43], v[72:79], v96
    s_cbranch_scc1 KA_CV1
    v_subrev_u32 v99, 960, v99
    v_add_u32 v110, 288, v110
    ds_read2_b32 v[40:41], v99 offset0:240 offset1:241
    ds_read2_b32 v[42:43], v99 offset0:242 offset1:243
    ds_read_b128 v[56:59], v110 offset:4320
    ds_read_b128 v[60:63], v110 offset:4384
    s_waitcnt lgkmcnt(0)
    v_smfmac_f32_32x32x32_bf16 v[128:143], v[40:43], v[56:63], v98
    ds_read2_b32 v[40:41], v99 offset0:224 offset1:225
    ds_read2_b32 v[42:43], v99 offset0:226 offset1:227
    ds_read_b128 v[56:59], v110 offset:4032
    ds_read_b128 v[60:63], v110 offset:4096
    s_waitcnt lgkmcnt(0)
    v_smfmac_f32_32x32x32_bf16 v[128:143], v[40:43], v[56:63], v97
    ds_read2_b32 v[40:41], v99 offset0:208 offset1:209
    ds_read2_b32 v[42:43], v99 offset0:210 offset1:211
    ds_read_b128 v[56:59], v110 offset:3744
    ds_read_b128 v[60:63], v110 offset:3808
    s_waitcnt lgkmcnt(0)
    v_smfmac_f32_32x32x32_bf16 v[128:143], v[40:43], v[56:63], v97
    ds_read2_b32 v[40:41], v99 offset0:192 offset1:193
    ds_read2_b32 v[42:43], v99 offset0:194 offset1:195
    ds_read_b128 v[56:59], v110 offset:3456
    ds_read_b128 v[60:63], v110 offset:3520
    s_waitcnt lgkmcnt(0)
    v_smfmac_f32_32x32x32_bf16 v[128:143], v[40:43], v[56:63], v97
    ds_read2_b32 v[40:41], v99 offset0:176 offset1:177
    ds_read2_b32 v[42:43], v99 offset0:178 offset1:179
    ds_read_b128 v[56:59], v110 offset:3168
    ds_read_b128 v[60:63], v110 offset:3232
    s_waitcnt lgkmcnt(0)
    v_smfmac_f32_32x32x32_bf16 v[128:143], v[40:43], v[56:63], v97
    ds_read2_b32 v[40:41], v99 offset0:160 offset1:161
    ds_read2_b32 v[42:43], v99 offset0:162 offset1:163
    ds_read_b128 v[56:59], v110 offset:2880
    ds_read_b128 v[60:63], v110 offset:2944
    s_waitcnt lgkmcnt(0)
    v_smfmac_f32_32x32x32_bf16 v[128:143], v[40:43], v[56:63], v97
    ds_read2_b32 v[40:41], v99 offset0:144 offset1:145
    ds_read2_b32 v[42:43], v99 offset0:146 offset1:147
    ds_read_b128 v[56:59], v110 offset:2592
    ds_read_b128 v[60:63], v110 offset:2656
    s_waitcnt lgkmcnt(0)
    v_smfmac_f32_32x32x32_bf16 v[128:143], v[40:43], v[56:63], v97
    ds_read2_b32 v[40:41], v99 offset0:128 offset1:129
    ds_read2_b32 v[42:43], v99 offset0:130 offset1:131
    ds_read_b128 v[56:59], v110 offset:2304
    ds_read_b128 v[60:63], v110 offset:2368
    s_waitcnt lgkmcnt(0)
    v_smfmac_f32_32x32x32_bf16 v[128:143], v[40:43], v[56:63], v97
    ds_read2_b32 v[40:41], v99 offset0:112 offset1:113
    ds_read2_b32 v[42:43], v99 offset0:114 offset1:115
    ds_read_b128 v[56:59], v110 offset:2016
    ds_read_b128 v[60:63], v110 offset:2080
    s_waitcnt lgkmcnt(0)
    v_smfmac_f32_32x32x32_bf16 v[128:143], v[40:43], v[56:63], v97
    ds_read2_b32 v[40:41], v99 offset0:96 offset1:97
    ds_read2_b32 v[42:43], v99 offset0:98 offset1:99
    ds_read_b128 v[56:59], v110 offset:1728
    ds_read_b128 v[60:63], v110 offset:1792
    s_waitcnt lgkmcnt(0)
    v_smfmac_f32_32x32x32_bf16 v[128:143], v[40:43], v[56:63], v97
    ds_read2_b32 v[40:41], v99 offset0:80 offset1:81
    ds_read2_b32 v[42:43], v99 offset0:82 offset1:83
    ds_read_b128 v[56:59], v110 offset:1440
    ds_read_b128 v[60:63], v110 offset:1504
    s_waitcnt lgkmcnt(0)
    v_smfmac_f32_32x32x32_bf16 v[128:143], v[40:43], v[56:63], v97
    ds_read2_b32 v[40:41], v99 offset0:64 offset1:65
    ds_read2_b32 v[42:43], v99 offset0:66 offset1:67
    ds_read_b128 v[56:59], v110 offset:1152
    ds_read_b128 v[60:63], v110 offset:1216
    s_waitcnt lgkmcnt(0)
    v_smfmac_f32_32x32x32_bf16 v[128:143], v[40:43], v[56:63], v97
    ds_read2_b32 v[40:41], v99 offset0:48 offset1:49
    ds_read2_b32 v[42:43], v99 offset0:50 offset1:51
    ds_read_b128 v[56:59], v110 offset:864
    ds_read_b128 v[60:63], v110 offset:928
    s_waitcnt lgkmcnt(0)
    v_smfmac_f32_32x32x32_bf16 v[128:143], v[40:43], v[56:63], v97
    ds_read2_b32 v[40:41], v99 offset0:32 offset1:33
    ds_read2_b32 v[42:43], v99 offset0:34 offset1:35
    ds_read_b128 v[56:59], v110 offset:576
    ds_read_b128 v[60:63], v110 offset:640
    s_waitcnt lgkmcnt(0)
    v_smfmac_f32_32x32x32_bf16 v[128:143], v[40:43], v[56:63], v97
    ds_read2_b32 v[40:41], v99 offset0:16 offset1:17
    ds_read2_b32 v[42:43], v99 offset0:18 offset1:19
    ds_read_b128 v[56:59], v110 offset:288
    ds_read_b128 v[60:63], v110 offset:352
    s_waitcnt lgkmcnt(0)
    v_smfmac_f32_32x32x32_bf16 v[128:143], v[40:43], v[56:63], v97
    ds_read2_b32 v[40:41], v99 offset0:0 offset1:1
    ds_read2_b32 v[42:43], v99 offset0:2 offset1:3
    ds_read_b128 v[56:59], v110 offset:0
    ds_read_b128 v[60:63], v110 offset:64
    s_waitcnt lgkmcnt(0)
    v_smfmac_f32_32x32x32_bf16 v[128:143], v[40:43], v[56:63], v97
KA_CVE:
    s_lshl_b32 s63, s54, 12
    s_add_u32 s63, s63, 73728
    v_add_u32 v13, s63, v4
    v_xor_b32 v14, 4096, v13
    s_mov_b32 s77, 1048576
KA_W36:
    ds_read_b32 v166, v164 offset:104
    s_sub_u32 s77, s77, 1
    s_cbranch_scc1 KA_E37
    s_waitcnt lgkmcnt(0)
    v_readfirstlane_b32 s76, v166
    s_cmp_lt_u32 s76, 4
    s_cbranch_scc1 KA_W36
KA_E37:
    s_cmp_eq_u32 s61, 0
    s_cbranch_scc0 KA_CVS
    ds_write_b128 v13, v[128:131] offset:0
    ds_write_b128 v13, v[132:135] offset:1024
    ds_write_b128 v13, v[136:139] offset:2048
    ds_write_b128 v13, v[140:143] offset:3072
    s_mov_b64 exec, 1
    ds_add_u32 v167, v165 offset:112
    s_mov_b64 exec, -1
    s_mov_b32 s77, 1048576
    s_branch KA_W38F
KA_W38:
    s_sleep 1
KA_W38F:
    ds_read_b32 v166, v167 offset:112
    s_sub_u32 s77, s77, 1
    s_cbranch_scc1 KA_E39
    s_waitcnt lgkmcnt(0)
    v_readfirstlane_b32 s76, v166
    s_cmp_lt_u32 s76, 2
    s_cbranch_scc1 KA_W38
KA_E39:
    ds_read_b128 v[128:131], v14 offset:0
    ds_read_b128 v[132:135], v14 offset:1024
    ds_read_b128 v[136:139], v14 offset:2048
    ds_read_b128 v[140:143], v14 offset:3072
    s_branch KA_CVJ
KA_CVS:
    ds_write_b128 v13, v[112:115] offset:0
    ds_write_b128 v13, v[116:119] offset:1024
    ds_write_b128 v13, v[120:123] offset:2048
    ds_write_b128 v13, v[124:127] offset:3072
    s_mov_b64 exec, 1
    ds_add_u32 v167, v165 offset:112
    s_mov_b64 exec, -1
    s_mov_b32 s77, 1048576
    s_branch KA_W40F
KA_W40:
    s_sleep 1
KA_W40F:
    ds_read_b32 v166, v167 offset:112
    s_sub_u32 s77, s77, 1
    s_cbranch_scc1 KA_E41
    s_waitcnt lgkmcnt(0)
    v_readfirstlane_b32 s76, v166
    s_cmp_lt_u32 s76, 2
    s_cbranch_scc1 KA_W40
KA_E41:
    ds_read_b128 v[112:115], v14 offset:0
    ds_read_b128 v[116:119], v14 offset:1024
    ds_read_b128 v[120:123], v14 offset:2048
    ds_read_b128 v[124:127], v14 offset:3072
KA_CVJ:
    s_lshl_b32 s56, s49, 2
    s_and_b32 s57, s50, 3
    s_add_u32 s56, s56, s57
    s_lshr_b32 s57, s50, 2
    s_lshl_b32 s72, s56, 11
    s_add_u32 s72, s72, 6832128
    s_lshl_b32 s65, s56, 1
    s_add_u32 s65, s65, s61
    s_lshl_b32 s63, s57, 1
    s_add_u32 s63, s63, s62
    s_lshl_b32 s74, s63, 6
    s_lshl_b32 s64, s65, 15
    s_add_u32 s74, s74, s64
    s_lshl_b32 s73, s57, 18
    s_lshl_b32 s64, s54, 16
    s_add_u32 s73, s73, s64
    s_lshl_b32 s64, s56, 7
    s_add_u32 s73, s73, s64
    s_add_u32 s73, s73, 8994816
    s_lshl_b32 s75, s65, 8
    s_add_u32 s75, s75, 6815744
    v_mov_b32 v155, s52
    s_lshl_b32 s63, s55, 13
    s_lshl_b32 s64, s54, 11
    s_add_u32 s63, s63, s64
    s_add_u32 s63, s63, 8994816
    s_waitcnt lgkmcnt(0)
    s_mov_b64 exec, 1
    ds_add_u32 v164, v165 offset:144
    s_mov_b64 exec, -1
    v_add_f32 v112, v112, v128
    v_add_f32 v113, v113, v129
    v_add_f32 v114, v114, v130
    v_add_f32 v115, v115, v131
    v_add_f32 v116, v116, v132
    v_add_f32 v117, v117, v133
    v_add_f32 v118, v118, v134
    v_add_f32 v119, v119, v135
    v_add_f32 v120, v120, v136
    v_add_f32 v121, v121, v137
    v_add_f32 v122, v122, v138
    v_add_f32 v123, v123, v139
    v_add_f32 v124, v124, v140
    v_add_f32 v125, v125, v141
    v_add_f32 v126, v126, v142
    v_add_f32 v127, v127, v143
    v_cvt_pk_bf16_f32 v64, v112, v113
    v_cvt_pk_bf16_f32 v65, v114, v115
    v_cvt_pk_bf16_f32 v66, v116, v117
    v_cvt_pk_bf16_f32 v67, v118, v119
    v_cvt_pk_bf16_f32 v68, v120, v121
    v_cvt_pk_bf16_f32 v69, v122, v123
    v_cvt_pk_bf16_f32 v70, v124, v125
    v_cvt_pk_bf16_f32 v71, v126, v127
    ds_write_b128 v108, v[64:67]
    ds_write_b128 v108, v[68:71] offset:64
    ds_read_b128 v[64:67], v151
    ds_read_b128 v[68:71], v151 offset:1024
    s_waitcnt lgkmcnt(0)
    buffer_store_dwordx4 v[64:67], v4, s[44:47], s63 offen sc1
    buffer_store_dwordx4 v[68:71], v4, s[44:47], s63 offen offset:1024 sc1
    s_lshl_b32 s63, s50, 11
    s_add_u32 s71, s63, 6832128
    s_lshl_b32 s70, s49, 7
    s_add_u32 s63, s71, s70
    s_mov_b32 s36, s26
    s_and_b32 s37, s27, 0xffff
    s_mov_b32 s38, 524288
    s_mov_b32 s39, 0x20000
    s_mov_b32 s40, s30
    s_and_b32 s41, s31, 0xffff
    s_mov_b32 s42, 2097152
    s_mov_b32 s43, 0x20000
    v_lshlrev_b32 v12, 2, s49
    s_mov_b32 s77, 1048576
    s_branch KA_W42F
KA_W42:
    s_sleep 4
KA_W42F:
    ds_read_b32 v166, v164 offset:144
    s_sub_u32 s77, s77, 1
    s_cbranch_scc1 KA_E43
    s_waitcnt lgkmcnt(0)
    v_readfirstlane_b32 s76, v166
    s_cmp_lt_u32 s76, 5
    s_cbranch_scc1 KA_W42
KA_E43:
    s_waitcnt vmcnt(0)
    s_mov_b64 exec, 1
    ds_add_rtn_u32 v166, v164, v165 offset:156
    s_waitcnt lgkmcnt(0)
    v_readfirstlane_b32 s76, v166
    s_cmp_lg_u32 s76, 3
    s_cbranch_scc1 KA_NCL
    buffer_store_dword v155, v156, s[44:47], s67 offen offset:2048 sc1
    buffer_store_dword v155, v12, s[44:47], s71 offen offset:1024 sc1
KA_NCL:
    s_mov_b64 exec, -1
    s_lshl_b32 s63, s50, 2
    s_add_u32 s63, s63, s54
    s_lshl_b32 s63, s63, 12
    s_add_u32 s64, s26, s63
    s_addc_u32 s65, s27, 0
    s_load_dwordx2 s[68:69], s[64:65], 60
    s_load_dwordx2 s[68:69], s[64:65], 188
    s_load_dwordx2 s[68:69], s[64:65], 316
    s_load_dwordx2 s[68:69], s[64:65], 444
    s_load_dwordx2 s[68:69], s[64:65], 572
    s_load_dwordx2 s[68:69], s[64:65], 700
    s_load_dwordx2 s[68:69], s[64:65], 828
    s_load_dwordx2 s[68:69], s[64:65], 956
    s_load_dwordx2 s[68:69], s[64:65], 1084
    s_load_dwordx2 s[68:69], s[64:65], 1212
    s_load_dwordx2 s[68:69], s[64:65], 1340
    s_load_dwordx2 s[68:69], s[64:65], 1468
    s_load_dwordx2 s[68:69], s[64:65], 1596
    s_load_dwordx2 s[68:69], s[64:65], 1724
    s_load_dwordx2 s[68:69], s[64:65], 1852
    s_load_dwordx2 s[68:69], s[64:65], 1980
    s_load_dwordx2 s[68:69], s[64:65], 2108
    s_load_dwordx2 s[68:69], s[64:65], 2236
    s_load_dwordx2 s[68:69], s[64:65], 2364
    s_load_dwordx2 s[68:69], s[64:65], 2492
    s_load_dwordx2 s[68:69], s[64:65], 2620
    s_load_dwordx2 s[68:69], s[64:65], 2748
    s_load_dwordx2 s[68:69], s[64:65], 2876
    s_load_dwordx2 s[68:69], s[64:65], 3004
    s_load_dwordx2 s[68:69], s[64:65], 3132
    s_load_dwordx2 s[68:69], s[64:65], 3260
    s_load_dwordx2 s[68:69], s[64:65], 3388
    s_load_dwordx2 s[68:69], s[64:65], 3516
    s_load_dwordx2 s[68:69], s[64:65], 3644
    s_load_dwordx2 s[68:69], s[64:65], 3772
    s_load_dwordx2 s[68:69], s[64:65], 3900
    s_load_dwordx2 s[68:69], s[64:65], 4028
    s_waitcnt lgkmcnt(0)
    s_mov_b32 s77, 1048576
    s_branch KA_W44F
KA_W44:
    s_sleep 16
KA_W44F:
    ds_read_b32 v166, v164 offset:96
    s_sub_u32 s77, s77, 1
    s_cbranch_scc1 KA_E45
    s_waitcnt lgkmcnt(0)
    v_readfirstlane_b32 s76, v166
    s_cmp_lt_u32 s76, 1
    s_cbranch_scc1 KA_W44
KA_E45:
    s_lshl_b32 s58, s54, 12
    s_add_u32 s58, s58, 18432
    s_lshl_b32 s59, s54, 15
    s_lshl_b32 s63, s57, 7
    s_add_u32 s59, s59, s63
    s_add_u32 s64, s50, 0
    s_and_b32 s64, s64, 3
    s_lshl_b32 s63, s64, 14
    s_add_u32 m0, s58, s63
    s_lshl_b32 s63, s64, 17
    s_add_u32 s63, s63, s59
    buffer_load_dwordx4 v144, s[36:39], s63 offen offset:0 lds
    buffer_load_dwordx4 v145, s[36:39], s63 offen offset:1024 lds
    s_waitcnt vmcnt(0)
    buffer_load_dwordx4 v146, s[36:39], s63 offen offset:2048 lds
    buffer_load_dwordx4 v147, s[36:39], s63 offen offset:3072 lds
    s_waitcnt vmcnt(0)
    s_add_u32 s64, s50, 1
    s_and_b32 s64, s64, 3
    s_lshl_b32 s63, s64, 14
    s_add_u32 m0, s58, s63
    s_lshl_b32 s63, s64, 17
    s_add_u32 s63, s63, s59
    buffer_load_dwordx4 v144, s[36:39], s63 offen offset:0 lds
    buffer_load_dwordx4 v145, s[36:39], s63 offen offset:1024 lds
    s_waitcnt vmcnt(0)
    buffer_load_dwordx4 v146, s[36:39], s63 offen offset:2048 lds
    buffer_load_dwordx4 v147, s[36:39], s63 offen offset:3072 lds
    s_waitcnt vmcnt(0)
    s_add_u32 s64, s50, 2
    s_and_b32 s64, s64, 3
    s_lshl_b32 s63, s64, 14
    s_add_u32 m0, s58, s63
    s_lshl_b32 s63, s64, 17
    s_add_u32 s63, s63, s59
    buffer_load_dwordx4 v144, s[36:39], s63 offen offset:0 lds
    buffer_load_dwordx4 v145, s[36:39], s63 offen offset:1024 lds
    s_waitcnt vmcnt(0)
    buffer_load_dwordx4 v146, s[36:39], s63 offen offset:2048 lds
    buffer_load_dwordx4 v147, s[36:39], s63 offen offset:3072 lds
    s_waitcnt vmcnt(0)
    s_add_u32 s64, s50, 3
    s_and_b32 s64, s64, 3
    s_lshl_b32 s63, s64, 14
    s_add_u32 m0, s58, s63
    s_lshl_b32 s63, s64, 17
    s_add_u32 s63, s63, s59
    buffer_load_dwordx4 v144, s[36:39], s63 offen offset:0 lds
    buffer_load_dwordx4 v145, s[36:39], s63 offen offset:1024 lds
    s_waitcnt vmcnt(0)
    buffer_load_dwordx4 v146, s[36:39], s63 offen offset:2048 lds
    buffer_load_dwordx4 v147, s[36:39], s63 offen offset:3072 lds
    s_waitcnt vmcnt(0)
    s_xor_b32 s63, s57, 4
    s_mul_i32 s63, s63, 851968
    s_add_u32 s63, s63, 788480
    s_add_u32 s64, s34, s63
    s_addc_u32 s65, s35, 0
    s_add_u32 s70, s72, 1024
    s_mov_b32 s77, 1048576
    s_branch KA_W46F
KA_W46:
    s_sleep 16
KA_W46F:
    ds_read_b32 v166, v164 offset:96
    s_sub_u32 s77, s77, 1
    s_cbranch_scc1 KA_E47
    s_waitcnt lgkmcnt(0)
    v_readfirstlane_b32 s76, v166
    s_cmp_lt_u32 s76, 1
    s_cbranch_scc1 KA_W46
KA_E47:
    s_mov_b32 s71, 0
    s_load_dwordx16 s[4:19], s[64:65], 0
    s_load_dwordx8 s[20:27], s[34:35], s70
    s_load_dword s68, s[64:65], 64
    s_waitcnt lgkmcnt(0)
    s_xor_b32 s4, s4, s52
    s_or_b32 s71, s71, s4
    s_xor_b32 s5, s5, s52
    s_or_b32 s71, s71, s5
    s_xor_b32 s6, s6, s52
    s_or_b32 s71, s71, s6
    s_xor_b32 s7, s7, s52
    s_or_b32 s71, s71, s7
    s_xor_b32 s8, s8, s52
    s_or_b32 s71, s71, s8
    s_xor_b32 s9, s9, s52
    s_or_b32 s71, s71, s9
    s_xor_b32 s10, s10, s52
    s_or_b32 s71, s71, s10
    s_xor_b32 s11, s11, s52
    s_or_b32 s71, s71, s11
    s_xor_b32 s12, s12, s52
    s_or_b32 s71, s71, s12
    s_xor_b32 s13, s13, s52
    s_or_b32 s71, s71, s13
    s_xor_b32 s14, s14, s52
    s_or_b32 s71, s71, s14
    s_xor_b32 s15, s15, s52
    s_or_b32 s71, s71, s15
    s_xor_b32 s16, s16, s52
    s_or_b32 s71, s71, s16
    s_xor_b32 s17, s17, s52
    s_or_b32 s71, s71, s17
    s_xor_b32 s18, s18, s52
    s_or_b32 s71, s71, s18
    s_xor_b32 s19, s19, s52
    s_or_b32 s71, s71, s19
    s_xor_b32 s20, s20, s52
    s_or_b32 s71, s71, s20
    s_xor_b32 s21, s21, s52
    s_or_b32 s71, s71, s21
    s_xor_b32 s22, s22, s52
    s_or_b32 s71, s71, s22
    s_xor_b32 s23, s23, s52
    s_or_b32 s71, s71, s23
    s_xor_b32 s24, s24, s52
    s_or_b32 s71, s71, s24
    s_xor_b32 s25, s25, s52
    s_or_b32 s71, s71, s25
    s_xor_b32 s26, s26, s52
    s_or_b32 s71, s71, s26
    s_xor_b32 s27, s27, s52
    s_or_b32 s71, s71, s27
    s_load_dwordx16 s[4:19], s[64:65], 64
    s_waitcnt lgkmcnt(0)
    s_xor_b32 s4, s4, s52
    s_or_b32 s71, s71, s4
    s_xor_b32 s5, s5, s52
    s_or_b32 s71, s71, s5
    s_xor_b32 s6, s6, s52
    s_or_b32 s71, s71, s6
    s_xor_b32 s7, s7, s52
    s_or_b32 s71, s71, s7
    s_xor_b32 s8, s8, s52
    s_or_b32 s71, s71, s8
    s_xor_b32 s9, s9, s52
    s_or_b32 s71, s71, s9
    s_xor_b32 s10, s10, s52
    s_or_b32 s71, s71, s10
    s_xor_b32 s11, s11, s52
    s_or_b32 s71, s71, s11
    s_xor_b32 s12, s12, s52
    s_or_b32 s71, s71, s12
    s_xor_b32 s13, s13, s52
    s_or_b32 s71, s71, s13
    s_xor_b32 s14, s14, s52
    s_or_b32 s71, s71, s14
    s_xor_b32 s15, s15, s52
    s_or_b32 s71, s71, s15
    s_xor_b32 s16, s16, s52
    s_or_b32 s71, s71, s16
    s_xor_b32 s17, s17, s52
    s_or_b32 s71, s71, s17
    s_xor_b32 s18, s18, s52
    s_or_b32 s71, s71, s18
    s_xor_b32 s19, s19, s52
    s_or_b32 s71, s71, s19
    s_cbranch_scc0 KA_PCD
    v_and_b32 v9, 7, v1
    v_lshlrev_b32 v9, 2, v9
    s_mov_b32 s69, 20000
KA_PC:
    s_sleep 32
    buffer_load_dword v10, v157, s[44:47], s63 offen sc1
    buffer_load_dword v11, v9, s[44:47], s70 offen sc1
    s_waitcnt vmcnt(0)
    v_cmp_ne_u32 vcc, s52, v10
    v_cmp_ne_u32 s[4:5], s52, v11
    s_or_b64 vcc, vcc, s[4:5]
    s_cbranch_scc0 KA_PCD
    s_sub_u32 s69, s69, 1
    s_cbranch_scc0 KA_PC
KA_PCD:
    s_lshl_b32 s58, s54, 11
    s_add_u32 m0, s58, 83968
    s_add_u32 s63, s73, 31744
    s_waitcnt vmcnt(0) lgkmcnt(0)
    buffer_load_dwordx4 v109, s[44:47], s73 offen sc1 lds
    buffer_load_dwordx4 v109, s[44:47], s63 offen offset:1024 sc1 lds
    buffer_load_dwordx2 v[14:15], v148, s[44:47], s75 offen sc1
    s_add_u32 m0, s60, 16
    s_mov_b64 exec, 1
    buffer_load_dword v154, s[44:47], 0 offen lds
    s_mov_b64 exec, -1
    s_lshl_b32 s58, s61, 12
    s_lshl_b32 s59, s56, 16
    s_add_u32 s59, s59, s58
    s_add_u32 s59, s59, 6897664
    s_waitcnt vmcnt(0)
    s_mov_b32 s77, 1048576
    s_branch KA_W48F
KA_W48:
    s_sleep 4
KA_W48F:
    ds_read_b128 v[160:163], v164 offset:16
    s_sub_u32 s77, s77, 1
    s_cbranch_scc1 KA_E49
    s_waitcnt lgkmcnt(0)
    v_or3_b32 v160, v160, v161, v162
    v_or_b32 v160, v160, v163
    v_cmp_ne_u32 vcc, 0, v160
    s_cbranch_vccnz KA_W48
KA_E49:
    ds_read_b128 v[32:35], v149
    ds_read_b128 v[36:39], v149 offset:64
    v_lshrrev_b32 v13, 16, v14
    v_or_b32 v13, v13, v14
    v_and_b32 v40, v13, v100
    v_and_b32 v41, v13, v101
    v_and_b32 v42, v13, v102
    v_and_b32 v43, v13, v103
    v_and_b32 v44, v13, v104
    v_and_b32 v45, v13, v105
    v_and_b32 v46, v13, v106
    v_and_b32 v47, v13, v107
    s_waitcnt lgkmcnt(0)
    s_nop 0
    v_mfma_f32_32x32x16_bf16 v[128:143], v[32:35], v[40:43], 0
    v_mfma_f32_32x32x16_bf16 v[128:143], v[36:39], v[44:47], v[128:143]
    v_mov_b32 v2, v153
    v_mov_b32 v5, v152
    s_lshl_b32 s63, s54, 12
    s_add_u32 s64, s63, 98304
    v_add_u32 v6, s64, v4
    s_xor_b32 s63, s63, 8192
    s_add_u32 s64, s63, 98304
    v_add_u32 v11, s64, v4
    s_lshl_b32 s63, s61, 2
    v_add_u32 v14, s63, v164
    v_mov_b32 v16, 0
    v_mov_b32 v17, 0
    v_mov_b32 v18, 0
    v_mov_b32 v19, 0
    s_nop 1
    v_mfma_f32_32x32x16_bf16 v[112:127], v[16:19], v[16:19], 0
    v_mfma_f32_32x32x16_bf16 v[144:159], v[16:19], v[16:19], 0
    s_mul_i32 s63, s54, 2560
    s_add_u32 s63, s63, 139264
    v_mul_u32_u24 v160, 80, v7
    v_lshl_add_u32 v160, v3, 4, v160
    v_add_u32 v160, s63, v160
    v_lshrrev_b32 v162, 2, v1
    v_and_b32 v163, 3, v1
    v_mul_u32_u24 v161, 80, v162
    v_lshl_add_u32 v161, v163, 4, v161
    v_add_u32 v161, s63, v161
    v_lshlrev_b32 v162, 10, v162
    v_lshl_add_u32 v162, v163, 4, v162
    s_lshl_b32 s4, 0x55, s62
    s_mov_b32 s7, 1048576
    s_mov_b32 s77, 1048576
    s_branch KA_W50F
KA_W50:
    s_sleep 8
KA_W50F:
    ds_read_b32 v166, v164 offset:148
    s_sub_u32 s77, s77, 1
    s_cbranch_scc1 KA_E51
    s_waitcnt lgkmcnt(0)
    v_readfirstlane_b32 s76, v166
    s_cmp_lt_u32 s76, 8
    s_cbranch_scc1 KA_W50
KA_E51:
KA_OL:
    ds_read_b32 v10, v164 offset:152
    s_sub_u32 s7, s7, 1
    s_cselect_b32 s6, 0xffff, 0
    s_waitcnt lgkmcnt(0)
    v_readfirstlane_b32 s5, v10
    s_or_b32 s5, s5, s6
    s_lshr_b32 s12, s5, 8
    s_and_b32 s5, s5, s4
    s_cbranch_scc0 KA_OL
    s_ff1_i32_b32 s8, s5
    s_lshl_b32 s63, s8, 13
    s_add_u32 s63, s63, s59
    buffer_load_dwordx4 v[48:51], v4, s[44:47], s63 offen offset:0 sc1
    buffer_load_dwordx4 v[52:55], v4, s[44:47], s63 offen offset:1024 sc1
    buffer_load_dwordx4 v[56:59], v4, s[44:47], s63 offen offset:2048 sc1
    buffer_load_dwordx4 v[60:63], v4, s[44:47], s63 offen offset:3072 sc1
    s_bitset0_b32 s4, s8
    s_bitset0_b32 s5, s8
    s_cmp_eq_u32 s5, 0
    s_cbranch_scc1 KA_OP1
    s_ff1_i32_b32 s9, s5
    s_lshl_b32 s63, s9, 13
    s_add_u32 s63, s63, s59
    buffer_load_dwordx4 v[64:67], v4, s[44:47], s63 offen offset:0 sc1
    buffer_load_dwordx4 v[68:71], v4, s[44:47], s63 offen offset:1024 sc1
    buffer_load_dwordx4 v[72:75], v4, s[44:47], s63 offen offset:2048 sc1
    buffer_load_dwordx4 v[76:79], v4, s[44:47], s63 offen offset:3072 sc1
    s_bitset0_b32 s4, s9
    s_bitset0_b32 s5, s9
    s_cmp_eq_u32 s5, 0
    s_cbranch_scc1 KA_OP2
    s_ff1_i32_b32 s10, s5
    s_lshl_b32 s63, s10, 13
    s_add_u32 s63, s63, s59
    buffer_load_dwordx4 v[80:83], v4, s[44:47], s63 offen offset:0 sc1
    buffer_load_dwordx4 v[84:87], v4, s[44:47], s63 offen offset:1024 sc1
    buffer_load_dwordx4 v[88:91], v4, s[44:47], s63 offen offset:2048 sc1
    buffer_load_dwordx4 v[92:95], v4, s[44:47], s63 offen offset:3072 sc1
    s_bitset0_b32 s4, s10
    s_bitset0_b32 s5, s10
    s_cmp_eq_u32 s5, 0
    s_cbranch_scc1 KA_OP3
    s_ff1_i32_b32 s11, s5
    s_lshl_b32 s63, s11, 13
    s_add_u32 s63, s63, s59
    buffer_load_dwordx4 v[96:99], v4, s[44:47], s63 offen offset:0 sc1
    buffer_load_dwordx4 v[100:103], v4, s[44:47], s63 offen offset:1024 sc1
    buffer_load_dwordx4 v[104:107], v4, s[44:47], s63 offen offset:2048 sc1
    buffer_load_dwordx4 v[108:111], v4, s[44:47], s63 offen offset:3072 sc1
    s_bitset0_b32 s4, s11
    s_bitset0_b32 s5, s11
KA_OP4:
    s_lshl_b32 s63, s8, 13
    v_add_u32 v12, s63, v5
    v_xor_b32 v13, 64, v12
    ds_read_b64_tr_b16 v[32:33], v13 offset:0
    ds_read_b64_tr_b16 v[34:35], v13 offset:1024
    ds_read_b64_tr_b16 v[36:37], v13 offset:2048
    ds_read_b64_tr_b16 v[38:39], v13 offset:3072
    ds_read_b64_tr_b16 v[40:41], v13 offset:4096
    ds_read_b64_tr_b16 v[42:43], v13 offset:5120
    ds_read_b64_tr_b16 v[44:45], v13 offset:6144
    ds_read_b64_tr_b16 v[46:47], v13 offset:7168
    s_waitcnt lgkmcnt(4)
    ds_read_b64_tr_b16 v[16:17], v12 offset:0
    ds_read_b64_tr_b16 v[18:19], v12 offset:1024
    ds_read_b64_tr_b16 v[20:21], v12 offset:2048
    ds_read_b64_tr_b16 v[22:23], v12 offset:3072
    ds_read_b64_tr_b16 v[24:25], v12 offset:4096
    ds_read_b64_tr_b16 v[26:27], v12 offset:5120
    ds_read_b64_tr_b16 v[28:29], v12 offset:6144
    ds_read_b64_tr_b16 v[30:31], v12 offset:7168
    s_waitcnt vmcnt(12) lgkmcnt(7)
    s_lshl_b32 s63, s9, 13
    v_add_u32 v12, s63, v5
    v_xor_b32 v13, 64, v12
    v_mfma_f32_32x32x16_bf16 v[144:159], v[32:35], v[48:51], v[144:159]
    ds_read_b64_tr_b16 v[32:33], v13 offset:0
    ds_read_b64_tr_b16 v[34:35], v13 offset:1024
    v_mfma_f32_32x32x16_bf16 v[144:159], v[36:39], v[52:55], v[144:159]
    ds_read_b64_tr_b16 v[36:37], v13 offset:2048
    ds_read_b64_tr_b16 v[38:39], v13 offset:3072
    v_mfma_f32_32x32x16_bf16 v[144:159], v[40:43], v[56:59], v[144:159]
    ds_read_b64_tr_b16 v[40:41], v13 offset:4096
    ds_read_b64_tr_b16 v[42:43], v13 offset:5120
    v_mfma_f32_32x32x16_bf16 v[144:159], v[44:47], v[60:63], v[144:159]
    ds_read_b64_tr_b16 v[44:45], v13 offset:6144
    ds_read_b64_tr_b16 v[46:47], v13 offset:7168
    s_waitcnt lgkmcnt(7)
    v_mfma_f32_32x32x16_bf16 v[112:127], v[16:19], v[48:51], v[112:127]
    ds_read_b64_tr_b16 v[16:17], v12 offset:0
    ds_read_b64_tr_b16 v[18:19], v12 offset:1024
    v_mfma_f32_32x32x16_bf16 v[112:127], v[20:23], v[52:55], v[112:127]
    ds_read_b64_tr_b16 v[20:21], v12 offset:2048
    ds_read_b64_tr_b16 v[22:23], v12 offset:3072
    v_mfma_f32_32x32x16_bf16 v[112:127], v[24:27], v[56:59], v[112:127]
    ds_read_b64_tr_b16 v[24:25], v12 offset:4096
    ds_read_b64_tr_b16 v[26:27], v12 offset:5120
    v_mfma_f32_32x32x16_bf16 v[112:127], v[28:31], v[60:63], v[112:127]
    ds_read_b64_tr_b16 v[28:29], v12 offset:6144
    ds_read_b64_tr_b16 v[30:31], v12 offset:7168
    s_waitcnt vmcnt(8) lgkmcnt(7)
    s_lshl_b32 s63, s10, 13
    v_add_u32 v12, s63, v5
    v_xor_b32 v13, 64, v12
    v_mfma_f32_32x32x16_bf16 v[144:159], v[32:35], v[64:67], v[144:159]
    ds_read_b64_tr_b16 v[32:33], v13 offset:0
    ds_read_b64_tr_b16 v[34:35], v13 offset:1024
    v_mfma_f32_32x32x16_bf16 v[144:159], v[36:39], v[68:71], v[144:159]
    ds_read_b64_tr_b16 v[36:37], v13 offset:2048
    ds_read_b64_tr_b16 v[38:39], v13 offset:3072
    v_mfma_f32_32x32x16_bf16 v[144:159], v[40:43], v[72:75], v[144:159]
    ds_read_b64_tr_b16 v[40:41], v13 offset:4096
    ds_read_b64_tr_b16 v[42:43], v13 offset:5120
    v_mfma_f32_32x32x16_bf16 v[144:159], v[44:47], v[76:79], v[144:159]
    ds_read_b64_tr_b16 v[44:45], v13 offset:6144
    ds_read_b64_tr_b16 v[46:47], v13 offset:7168
    s_waitcnt lgkmcnt(7)
    v_mfma_f32_32x32x16_bf16 v[112:127], v[16:19], v[64:67], v[112:127]
    ds_read_b64_tr_b16 v[16:17], v12 offset:0
    ds_read_b64_tr_b16 v[18:19], v12 offset:1024
    v_mfma_f32_32x32x16_bf16 v[112:127], v[20:23], v[68:71], v[112:127]
    ds_read_b64_tr_b16 v[20:21], v12 offset:2048
    ds_read_b64_tr_b16 v[22:23], v12 offset:3072
    v_mfma_f32_32x32x16_bf16 v[112:127], v[24:27], v[72:75], v[112:127]
    ds_read_b64_tr_b16 v[24:25], v12 offset:4096
    ds_read_b64_tr_b16 v[26:27], v12 offset:5120
    v_mfma_f32_32x32x16_bf16 v[112:127], v[28:31], v[76:79], v[112:127]
    ds_read_b64_tr_b16 v[28:29], v12 offset:6144
    ds_read_b64_tr_b16 v[30:31], v12 offset:7168
    s_waitcnt vmcnt(4) lgkmcnt(7)
    s_lshl_b32 s63, s11, 13
    v_add_u32 v12, s63, v5
    v_xor_b32 v13, 64, v12
    v_mfma_f32_32x32x16_bf16 v[144:159], v[32:35], v[80:83], v[144:159]
    ds_read_b64_tr_b16 v[32:33], v13 offset:0
    ds_read_b64_tr_b16 v[34:35], v13 offset:1024
    v_mfma_f32_32x32x16_bf16 v[144:159], v[36:39], v[84:87], v[144:159]
    ds_read_b64_tr_b16 v[36:37], v13 offset:2048
    ds_read_b64_tr_b16 v[38:39], v13 offset:3072
    v_mfma_f32_32x32x16_bf16 v[144:159], v[40:43], v[88:91], v[144:159]
    ds_read_b64_tr_b16 v[40:41], v13 offset:4096
    ds_read_b64_tr_b16 v[42:43], v13 offset:5120
    v_mfma_f32_32x32x16_bf16 v[144:159], v[44:47], v[92:95], v[144:159]
    ds_read_b64_tr_b16 v[44:45], v13 offset:6144
    ds_read_b64_tr_b16 v[46:47], v13 offset:7168
    s_waitcnt lgkmcnt(7)
    v_mfma_f32_32x32x16_bf16 v[112:127], v[16:19], v[80:83], v[112:127]
    ds_read_b64_tr_b16 v[16:17], v12 offset:0
    ds_read_b64_tr_b16 v[18:19], v12 offset:1024
    v_mfma_f32_32x32x16_bf16 v[112:127], v[20:23], v[84:87], v[112:127]
    ds_read_b64_tr_b16 v[20:21], v12 offset:2048
    ds_read_b64_tr_b16 v[22:23], v12 offset:3072
    v_mfma_f32_32x32x16_bf16 v[112:127], v[24:27], v[88:91], v[112:127]
    ds_read_b64_tr_b16 v[24:25], v12 offset:4096
    ds_read_b64_tr_b16 v[26:27], v12 offset:5120
    v_mfma_f32_32x32x16_bf16 v[112:127], v[28:31], v[92:95], v[112:127]
    ds_read_b64_tr_b16 v[28:29], v12 offset:6144
    ds_read_b64_tr_b16 v[30:31], v12 offset:7168
    s_waitcnt vmcnt(0) lgkmcnt(7)
    v_mfma_f32_32x32x16_bf16 v[144:159], v[32:35], v[96:99], v[144:159]
    v_mfma_f32_32x32x16_bf16 v[144:159], v[36:39], v[100:103], v[144:159]
    v_mfma_f32_32x32x16_bf16 v[144:159], v[40:43], v[104:107], v[144:159]
    v_mfma_f32_32x32x16_bf16 v[144:159], v[44:47], v[108:111], v[144:159]
    s_waitcnt lgkmcnt(0)
    v_mfma_f32_32x32x16_bf16 v[112:127], v[16:19], v[96:99], v[112:127]
    v_mfma_f32_32x32x16_bf16 v[112:127], v[20:23], v[100:103], v[112:127]
    v_mfma_f32_32x32x16_bf16 v[112:127], v[24:27], v[104:107], v[112:127]
    v_mfma_f32_32x32x16_bf16 v[112:127], v[28:31], v[108:111], v[112:127]
    s_cmp_lg_u32 s4, 0
    s_cbranch_scc1 KA_OL
    s_branch KA_OD
KA_OP3:
    s_lshl_b32 s63, s8, 13
    v_add_u32 v12, s63, v5
    v_xor_b32 v13, 64, v12
    ds_read_b64_tr_b16 v[32:33], v13 offset:0
    ds_read_b64_tr_b16 v[34:35], v13 offset:1024
    ds_read_b64_tr_b16 v[36:37], v13 offset:2048
    ds_read_b64_tr_b16 v[38:39], v13 offset:3072
    ds_read_b64_tr_b16 v[40:41], v13 offset:4096
    ds_read_b64_tr_b16 v[42:43], v13 offset:5120
    ds_read_b64_tr_b16 v[44:45], v13 offset:6144
    ds_read_b64_tr_b16 v[46:47], v13 offset:7168
    s_waitcnt lgkmcnt(4)
    ds_read_b64_tr_b16 v[16:17], v12 offset:0
    ds_read_b64_tr_b16 v[18:19], v12 offset:1024
    ds_read_b64_tr_b16 v[20:21], v12 offset:2048
    ds_read_b64_tr_b16 v[22:23], v12 offset:3072
    ds_read_b64_tr_b16 v[24:25], v12 offset:4096
    ds_read_b64_tr_b16 v[26:27], v12 offset:5120
    ds_read_b64_tr_b16 v[28:29], v12 offset:6144
    ds_read_b64_tr_b16 v[30:31], v12 offset:7168
    s_waitcnt vmcnt(8) lgkmcnt(7)
    s_lshl_b32 s63, s9, 13
    v_add_u32 v12, s63, v5
    v_xor_b32 v13, 64, v12
    v_mfma_f32_32x32x16_bf16 v[144:159], v[32:35], v[48:51], v[144:159]
    ds_read_b64_tr_b16 v[32:33], v13 offset:0
    ds_read_b64_tr_b16 v[34:35], v13 offset:1024
    v_mfma_f32_32x32x16_bf16 v[144:159], v[36:39], v[52:55], v[144:159]
    ds_read_b64_tr_b16 v[36:37], v13 offset:2048
    ds_read_b64_tr_b16 v[38:39], v13 offset:3072
    v_mfma_f32_32x32x16_bf16 v[144:159], v[40:43], v[56:59], v[144:159]
    ds_read_b64_tr_b16 v[40:41], v13 offset:4096
    ds_read_b64_tr_b16 v[42:43], v13 offset:5120
    v_mfma_f32_32x32x16_bf16 v[144:159], v[44:47], v[60:63], v[144:159]
    ds_read_b64_tr_b16 v[44:45], v13 offset:6144
    ds_read_b64_tr_b16 v[46:47], v13 offset:7168
    s_waitcnt lgkmcnt(7)
    v_mfma_f32_32x32x16_bf16 v[112:127], v[16:19], v[48:51], v[112:127]
    ds_read_b64_tr_b16 v[16:17], v12 offset:0
    ds_read_b64_tr_b16 v[18:19], v12 offset:1024
    v_mfma_f32_32x32x16_bf16 v[112:127], v[20:23], v[52:55], v[112:127]
    ds_read_b64_tr_b16 v[20:21], v12 offset:2048
    ds_read_b64_tr_b16 v[22:23], v12 offset:3072
    v_mfma_f32_32x32x16_bf16 v[112:127], v[24:27], v[56:59], v[112:127]
    ds_read_b64_tr_b16 v[24:25], v12 offset:4096
    ds_read_b64_tr_b16 v[26:27], v12 offset:5120
    v_mfma_f32_32x32x16_bf16 v[112:127], v[28:31], v[60:63], v[112:127]
    ds_read_b64_tr_b16 v[28:29], v12 offset:6144
    ds_read_b64_tr_b16 v[30:31], v12 offset:7168
    s_waitcnt vmcnt(4) lgkmcnt(7)
    s_lshl_b32 s63, s10, 13
    v_add_u32 v12, s63, v5
    v_xor_b32 v13, 64, v12
    v_mfma_f32_32x32x16_bf16 v[144:159], v[32:35], v[64:67], v[144:159]
    ds_read_b64_tr_b16 v[32:33], v13 offset:0
    ds_read_b64_tr_b16 v[34:35], v13 offset:1024
    v_mfma_f32_32x32x16_bf16 v[144:159], v[36:39], v[68:71], v[144:159]
    ds_read_b64_tr_b16 v[36:37], v13 offset:2048
    ds_read_b64_tr_b16 v[38:39], v13 offset:3072
    v_mfma_f32_32x32x16_bf16 v[144:159], v[40:43], v[72:75], v[144:159]
    ds_read_b64_tr_b16 v[40:41], v13 offset:4096
    ds_read_b64_tr_b16 v[42:43], v13 offset:5120
    v_mfma_f32_32x32x16_bf16 v[144:159], v[44:47], v[76:79], v[144:159]
    ds_read_b64_tr_b16 v[44:45], v13 offset:6144
    ds_read_b64_tr_b16 v[46:47], v13 offset:7168
    s_waitcnt lgkmcnt(7)
    v_mfma_f32_32x32x16_bf16 v[112:127], v[16:19], v[64:67], v[112:127]
    ds_read_b64_tr_b16 v[16:17], v12 offset:0
    ds_read_b64_tr_b16 v[18:19], v12 offset:1024
    v_mfma_f32_32x32x16_bf16 v[112:127], v[20:23], v[68:71], v[112:127]
    ds_read_b64_tr_b16 v[20:21], v12 offset:2048
    ds_read_b64_tr_b16 v[22:23], v12 offset:3072
    v_mfma_f32_32x32x16_bf16 v[112:127], v[24:27], v[72:75], v[112:127]
    ds_read_b64_tr_b16 v[24:25], v12 offset:4096
    ds_read_b64_tr_b16 v[26:27], v12 offset:5120
    v_mfma_f32_32x32x16_bf16 v[112:127], v[28:31], v[76:79], v[112:127]
    ds_read_b64_tr_b16 v[28:29], v12 offset:6144
    ds_read_b64_tr_b16 v[30:31], v12 offset:7168
    s_waitcnt vmcnt(0) lgkmcnt(7)
    v_mfma_f32_32x32x16_bf16 v[144:159], v[32:35], v[80:83], v[144:159]
    v_mfma_f32_32x32x16_bf16 v[144:159], v[36:39], v[84:87], v[144:159]
    v_mfma_f32_32x32x16_bf16 v[144:159], v[40:43], v[88:91], v[144:159]
    v_mfma_f32_32x32x16_bf16 v[144:159], v[44:47], v[92:95], v[144:159]
    s_waitcnt lgkmcnt(0)
    v_mfma_f32_32x32x16_bf16 v[112:127], v[16:19], v[80:83], v[112:127]
    v_mfma_f32_32x32x16_bf16 v[112:127], v[20:23], v[84:87], v[112:127]
    v_mfma_f32_32x32x16_bf16 v[112:127], v[24:27], v[88:91], v[112:127]
    v_mfma_f32_32x32x16_bf16 v[112:127], v[28:31], v[92:95], v[112:127]
    s_cmp_lg_u32 s4, 0
    s_cbranch_scc1 KA_OL
    s_branch KA_OD
KA_OP2:
    s_lshl_b32 s63, s8, 13
    v_add_u32 v12, s63, v5
    v_xor_b32 v13, 64, v12
    ds_read_b64_tr_b16 v[32:33], v13 offset:0
    ds_read_b64_tr_b16 v[34:35], v13 offset:1024
    ds_read_b64_tr_b16 v[36:37], v13 offset:2048
    ds_read_b64_tr_b16 v[38:39], v13 offset:3072
    ds_read_b64_tr_b16 v[40:41], v13 offset:4096
    ds_read_b64_tr_b16 v[42:43], v13 offset:5120
    ds_read_b64_tr_b16 v[44:45], v13 offset:6144
    ds_read_b64_tr_b16 v[46:47], v13 offset:7168
    s_waitcnt lgkmcnt(4)
    ds_read_b64_tr_b16 v[16:17], v12 offset:0
    ds_read_b64_tr_b16 v[18:19], v12 offset:1024
    ds_read_b64_tr_b16 v[20:21], v12 offset:2048
    ds_read_b64_tr_b16 v[22:23], v12 offset:3072
    ds_read_b64_tr_b16 v[24:25], v12 offset:4096
    ds_read_b64_tr_b16 v[26:27], v12 offset:5120
    ds_read_b64_tr_b16 v[28:29], v12 offset:6144
    ds_read_b64_tr_b16 v[30:31], v12 offset:7168
    s_waitcnt vmcnt(4) lgkmcnt(7)
    s_lshl_b32 s63, s9, 13
    v_add_u32 v12, s63, v5
    v_xor_b32 v13, 64, v12
    v_mfma_f32_32x32x16_bf16 v[144:159], v[32:35], v[48:51], v[144:159]
    ds_read_b64_tr_b16 v[32:33], v13 offset:0
    ds_read_b64_tr_b16 v[34:35], v13 offset:1024
    v_mfma_f32_32x32x16_bf16 v[144:159], v[36:39], v[52:55], v[144:159]
    ds_read_b64_tr_b16 v[36:37], v13 offset:2048
    ds_read_b64_tr_b16 v[38:39], v13 offset:3072
    v_mfma_f32_32x32x16_bf16 v[144:159], v[40:43], v[56:59], v[144:159]
    ds_read_b64_tr_b16 v[40:41], v13 offset:4096
    ds_read_b64_tr_b16 v[42:43], v13 offset:5120
    v_mfma_f32_32x32x16_bf16 v[144:159], v[44:47], v[60:63], v[144:159]
    ds_read_b64_tr_b16 v[44:45], v13 offset:6144
    ds_read_b64_tr_b16 v[46:47], v13 offset:7168
    s_waitcnt lgkmcnt(7)
    v_mfma_f32_32x32x16_bf16 v[112:127], v[16:19], v[48:51], v[112:127]
    ds_read_b64_tr_b16 v[16:17], v12 offset:0
    ds_read_b64_tr_b16 v[18:19], v12 offset:1024
    v_mfma_f32_32x32x16_bf16 v[112:127], v[20:23], v[52:55], v[112:127]
    ds_read_b64_tr_b16 v[20:21], v12 offset:2048
    ds_read_b64_tr_b16 v[22:23], v12 offset:3072
    v_mfma_f32_32x32x16_bf16 v[112:127], v[24:27], v[56:59], v[112:127]
    ds_read_b64_tr_b16 v[24:25], v12 offset:4096
    ds_read_b64_tr_b16 v[26:27], v12 offset:5120
    v_mfma_f32_32x32x16_bf16 v[112:127], v[28:31], v[60:63], v[112:127]
    ds_read_b64_tr_b16 v[28:29], v12 offset:6144
    ds_read_b64_tr_b16 v[30:31], v12 offset:7168
    s_waitcnt vmcnt(0) lgkmcnt(7)
    v_mfma_f32_32x32x16_bf16 v[144:159], v[32:35], v[64:67], v[144:159]
    v_mfma_f32_32x32x16_bf16 v[144:159], v[36:39], v[68:71], v[144:159]
    v_mfma_f32_32x32x16_bf16 v[144:159], v[40:43], v[72:75], v[144:159]
    v_mfma_f32_32x32x16_bf16 v[144:159], v[44:47], v[76:79], v[144:159]
    s_waitcnt lgkmcnt(0)
    v_mfma_f32_32x32x16_bf16 v[112:127], v[16:19], v[64:67], v[112:127]
    v_mfma_f32_32x32x16_bf16 v[112:127], v[20:23], v[68:71], v[112:127]
    v_mfma_f32_32x32x16_bf16 v[112:127], v[24:27], v[72:75], v[112:127]
    v_mfma_f32_32x32x16_bf16 v[112:127], v[28:31], v[76:79], v[112:127]
    s_cmp_lg_u32 s4, 0
    s_cbranch_scc1 KA_OL
    s_branch KA_OD
KA_OP1:
    s_lshl_b32 s63, s8, 13
    v_add_u32 v12, s63, v5
    v_xor_b32 v13, 64, v12
    ds_read_b64_tr_b16 v[32:33], v13 offset:0
    ds_read_b64_tr_b16 v[34:35], v13 offset:1024
    ds_read_b64_tr_b16 v[36:37], v13 offset:2048
    ds_read_b64_tr_b16 v[38:39], v13 offset:3072
    ds_read_b64_tr_b16 v[40:41], v13 offset:4096
    ds_read_b64_tr_b16 v[42:43], v13 offset:5120
    ds_read_b64_tr_b16 v[44:45], v13 offset:6144
    ds_read_b64_tr_b16 v[46:47], v13 offset:7168
    s_waitcnt lgkmcnt(4)
    ds_read_b64_tr_b16 v[16:17], v12 offset:0
    ds_read_b64_tr_b16 v[18:19], v12 offset:1024
    ds_read_b64_tr_b16 v[20:21], v12 offset:2048
    ds_read_b64_tr_b16 v[22:23], v12 offset:3072
    ds_read_b64_tr_b16 v[24:25], v12 offset:4096
    ds_read_b64_tr_b16 v[26:27], v12 offset:5120
    ds_read_b64_tr_b16 v[28:29], v12 offset:6144
    ds_read_b64_tr_b16 v[30:31], v12 offset:7168
    s_waitcnt vmcnt(0) lgkmcnt(7)
    v_mfma_f32_32x32x16_bf16 v[144:159], v[32:35], v[48:51], v[144:159]
    v_mfma_f32_32x32x16_bf16 v[144:159], v[36:39], v[52:55], v[144:159]
    v_mfma_f32_32x32x16_bf16 v[144:159], v[40:43], v[56:59], v[144:159]
    v_mfma_f32_32x32x16_bf16 v[144:159], v[44:47], v[60:63], v[144:159]
    s_waitcnt lgkmcnt(0)
    v_mfma_f32_32x32x16_bf16 v[112:127], v[16:19], v[48:51], v[112:127]
    v_mfma_f32_32x32x16_bf16 v[112:127], v[20:23], v[52:55], v[112:127]
    v_mfma_f32_32x32x16_bf16 v[112:127], v[24:27], v[56:59], v[112:127]
    v_mfma_f32_32x32x16_bf16 v[112:127], v[28:31], v[60:63], v[112:127]
    s_cmp_lg_u32 s4, 0
    s_cbranch_scc1 KA_OL
KA_OD:
    s_nop 4
    ds_write_b128 v6, v[144:147] offset:0
    ds_write_b128 v6, v[148:151] offset:1024
    ds_write_b128 v6, v[152:155] offset:2048
    ds_write_b128 v6, v[156:159] offset:3072
    s_mov_b64 exec, 1
    ds_add_u32 v14, v165 offset:168
    s_mov_b64 exec, -1
    v_fmac_f32 v128, v15, v112
    v_fmac_f32 v129, v15, v113
    v_fmac_f32 v130, v15, v114
    v_fmac_f32 v131, v15, v115
    v_fmac_f32 v132, v15, v116
    v_fmac_f32 v133, v15, v117
    v_fmac_f32 v134, v15, v118
    v_fmac_f32 v135, v15, v119
    v_fmac_f32 v136, v15, v120
    v_fmac_f32 v137, v15, v121
    v_fmac_f32 v138, v15, v122
    v_fmac_f32 v139, v15, v123
    v_fmac_f32 v140, v15, v124
    v_fmac_f32 v141, v15, v125
    v_fmac_f32 v142, v15, v126
    v_fmac_f32 v143, v15, v127
    s_mov_b32 s77, 1048576
KA_W52:
    ds_read_b32 v166, v14 offset:168
    s_sub_u32 s77, s77, 1
    s_cbranch_scc1 KA_E53
    s_waitcnt lgkmcnt(0)
    v_readfirstlane_b32 s76, v166
    s_cmp_lt_u32 s76, 2
    s_cbranch_scc1 KA_W52
KA_E53:
    ds_read_b128 v[144:147], v11 offset:0
    ds_read_b128 v[148:151], v11 offset:1024
    ds_read_b128 v[152:155], v11 offset:2048
    ds_read_b128 v[156:159], v11 offset:3072
    s_waitcnt lgkmcnt(3)
    v_fmac_f32 v128, v15, v144
    v_fmac_f32 v129, v15, v145
    v_fmac_f32 v130, v15, v146
    v_fmac_f32 v131, v15, v147
    s_waitcnt lgkmcnt(2)
    v_fmac_f32 v132, v15, v148
    v_fmac_f32 v133, v15, v149
    v_fmac_f32 v134, v15, v150
    v_fmac_f32 v135, v15, v151
    s_waitcnt lgkmcnt(1)
    v_fmac_f32 v136, v15, v152
    v_fmac_f32 v137, v15, v153
    v_fmac_f32 v138, v15, v154
    v_fmac_f32 v139, v15, v155
    s_waitcnt lgkmcnt(0)
    v_fmac_f32 v140, v15, v156
    v_fmac_f32 v141, v15, v157
    v_fmac_f32 v142, v15, v158
    v_fmac_f32 v143, v15, v159
    v_cvt_pk_bf16_f32 v32, v128, v129
    v_cvt_pk_bf16_f32 v33, v130, v131
    v_cvt_pk_bf16_f32 v34, v132, v133
    v_cvt_pk_bf16_f32 v35, v134, v135
    v_cvt_pk_bf16_f32 v36, v136, v137
    v_cvt_pk_bf16_f32 v37, v138, v139
    v_cvt_pk_bf16_f32 v38, v140, v141
    v_cvt_pk_bf16_f32 v39, v142, v143
    s_nop 1
    v_permlane32_swap_b32 v32, v34
    v_permlane32_swap_b32 v33, v35
    v_permlane32_swap_b32 v36, v38
    v_permlane32_swap_b32 v37, v39
    ds_write_b128 v160, v[32:35]
    ds_write_b128 v160, v[36:39] offset:32
    ds_read_b128 v[32:35], v161
    ds_read_b128 v[36:39], v161 offset:1280
    s_add_u32 s75, s74, 16384
    s_waitcnt lgkmcnt(1)
    buffer_store_dwordx4 v[32:35], v162, s[40:43], s74 offen sc1
    s_waitcnt lgkmcnt(0)
    buffer_store_dwordx4 v[36:39], v162, s[40:43], s75 offen sc1
KA_AUXEND:
    s_endpgm
KA_END:
    s_endpgm
.section .rodata,"a"
.p2align 6
.amdhsa_kernel gated_mix__ssm_conv_s4__softmax_full_mha__prompt_kernel
  .amdhsa_next_free_vgpr 168
  .amdhsa_next_free_sgpr 102
  .amdhsa_accum_offset 168
  .amdhsa_group_segment_fixed_size 0
  .amdhsa_kernarg_size 128
  .amdhsa_user_sgpr_count 2
  .amdhsa_user_sgpr_kernarg_segment_ptr 1
  .amdhsa_system_sgpr_workgroup_id_x 1
.end_amdhsa_kernel
```
